```python
import torch

def _softmax(x, axis=-1):
    return torch.softmax(x, dim=axis)
def _gelu(x):
    return torch.nn.functional.gelu(x, approximate="tanh")
def _silu(x):
    return torch.nn.functional.silu(x)
def _sigmoid(x):
    return torch.sigmoid(x)
def _layernorm(x, axis=-1, eps=1e-5):
    m = x.mean(dim=axis, keepdim=True)
    v = x.var(dim=axis, keepdim=True, unbiased=False)
    return (x - m) / torch.sqrt(v + eps)
def _scatter_add(tgt, idx, src, axis=0):
    return tgt.clone().index_add_(axis, idx, src)
def _segment_sum(src, seg, n):
    out = torch.zeros((n,) + src.shape[1:], dtype=src.dtype)
    return out.index_add_(0, seg, src)
def _pad(x, pw):
    flat = tuple(v for pair in reversed(pw) for v in pair)
    return torch.nn.functional.pad(x, flat)

kernel_name = 'recurrent_scan__compressed_kv_cla__dense_activation_gelu__decode'

def setup_inputs():

    _w = (lambda a: (lambda t: t.to(torch.bfloat16) if t.is_floating_point() else t)(torch.as_tensor(a)))
    def _A_setup():
        B, H, Sq, Sk, D, M = 1, 32, 1, 16384, 128, 576
        Dc = 4 * D
        return {
            "x": _w((lambda *s: torch.randn(*s, dtype=torch.bfloat16) * 0.1)(B, Sq, M)),
            "c_kv": _w((lambda *s: torch.randn(*s, dtype=torch.bfloat16) * 3.2)(B, Sk, Dc)),
            "w_q": _w((lambda *s: torch.randn(*s, dtype=torch.bfloat16) * 0.8)(M, H, D) * (M ** -0.5)),
            "w_uk": _w((lambda *s: torch.randn(*s, dtype=torch.bfloat16) * 0.8)(Dc, H, D) * (Dc ** -0.5)),
            "w_uv": _w((lambda *s: torch.randn(*s, dtype=torch.bfloat16) * 3.2)(Dc, H, D) * (Dc ** -0.5)),
            "w_o": _w((lambda *s: torch.randn(*s, dtype=torch.bfloat16) * 3.2)(H, D, M) * ((H * D) ** -0.5)),
        }
    _A_in = _A_setup()

    def _B_setup():
        B, S, D, F = 1, 1, 576, 4608
        return {
            "x": _w((lambda *s: torch.randn(*s, dtype=torch.bfloat16) * 0.1)(B, S, D)),
            "w1": _w((lambda *s: torch.randn(*s, dtype=torch.bfloat16) * 3.2)(D, F) * (D ** -0.5)),
            "b1": _w((lambda *s: torch.randn(*s, dtype=torch.bfloat16) * 3.2)(F) * 0.01),
            "w2": _w((lambda *s: torch.randn(*s, dtype=torch.bfloat16) * 0.8)(F, D) * (F ** -0.5)),
            "b2": _w((lambda *s: torch.randn(*s, dtype=torch.bfloat16) * 0.8)(D) * 0.01),
        }
    _B_in = _B_setup()

    return {
        "A_x": _A_in["x"],
        "A_c_kv": _A_in["c_kv"],
        "A_w_q": _A_in["w_q"],
        "A_w_uk": _A_in["w_uk"],
        "A_w_uv": _A_in["w_uv"],
        "A_w_o": _A_in["w_o"],
        "B_x": _B_in["x"],
        "B_w1": _B_in["w1"],
        "B_b1": _B_in["b1"],
        "B_w2": _B_in["w2"],
        "B_b2": _B_in["b2"],
    }

def reference(A_x, A_c_kv, A_w_q, A_w_uk, A_w_uv, A_w_o, B_x, B_w1, B_b1, B_w2, B_b2):
    def _A_ref(x, c_kv, w_q, w_uk, w_uv, w_o):
        B, Sq, M = x.shape[0], x.shape[1], x.shape[2]
        Sk = c_kv.shape[1]
        H, D = w_q.shape[1], w_q.shape[2]
        q = torch.einsum("bqm,mhd->bhqd", x, w_q)
        k = torch.einsum("bkc,chd->bhkd", c_kv, w_uk)
        v = torch.einsum("bkc,chd->bhkd", c_kv, w_uv)
        scores = torch.einsum("bhqd,bhkd->bhqk", q, k) * (D ** -0.5)
        off = Sk - Sq
        qi = torch.arange(Sq)[:, None]
        kj = torch.arange(Sk)[None, :]
        cmask = kj <= (qi + off)
        scores = torch.where(cmask[None, None], scores, -1e9)
        p = _softmax(scores, axis=-1)
        ctx = torch.einsum("bhqk,bhkd->bhqd", p, v)
        return torch.einsum("bhqd,hdm->bqm", ctx, w_o)

    def _B_ref(x, w1, b1, w2, b2):
        h = torch.einsum("bsd,df->bsf", x, w1) + b1
        h = _gelu(h)
        return torch.einsum("bsf,fd->bsd", h, w2) + b2

    x = A_x
    xn = _layernorm(x, axis=-1)
    s = _A_ref(xn, A_c_kv, A_w_q, A_w_uk, A_w_uv, A_w_o)
    g = _silu(_B_ref(xn, B_w1, B_b1, B_w2, B_b2))
    return x + s * g
```

```asm
; @launch grid=(256,1,1) block=(512,1,1) lds=163840
.amdgcn_target "amdgcn-amd-amdhsa--gfx950"
.text
.globl recurrent_scan__compressed_kv_cla__dense_activation_gelu__decode_kernel
.p2align 8
.type recurrent_scan__compressed_kv_cla__dense_activation_gelu__decode_kernel,@function
recurrent_scan__compressed_kv_cla__dense_activation_gelu__decode_kernel:
s_cmp_ge_u32 s2, 256
s_cbranch_scc1 L_exit
s_load_dwordx16 s[64:79], s[0:1], 0
s_load_dwordx8 s[80:87], s[0:1], 64
s_load_dwordx4 s[88:91], s[0:1], 96
v_lshrrev_b32 v2, 6, v0
v_and_b32 v1, 63, v0
v_readfirstlane_b32 s3, v2
s_getpc_b64 s[32:33]
L_pc:
s_lshr_b32 s34, s2, 3
s_sub_u32 s34, 31, s34
s_cmp_lg_u32 s3, 7
s_cbranch_scc1 L_nopf
s_cmp_ge_u32 s34, (L_codeend-recurrent_scan__compressed_kv_cla__dense_activation_gelu__decode_kernel)/1024
s_cbranch_scc1 L_nopf
s_sub_u32 s32, s32, L_pc-recurrent_scan__compressed_kv_cla__dense_activation_gelu__decode_kernel
s_subb_u32 s33, s33, 0
s_lshl_b32 s34, s34, 10
v_lshl_add_u32 v251, v1, 4, s34
global_load_dwordx4 v[252:255], v251, s[32:33]
L_nopf:
v_and_b32 v2, 15, v0
v_lshrrev_b32 v3, 4, v1
s_and_b32 s93, s2, 7
s_lshr_b32 s94, s2, 3
s_xor_b32 s94, s94, 16
s_mov_b32 s95, 1000000
s_mov_b32 s30, 268435456
s_mov_b32 s31, 0x20000
s_cmp_lt_u32 s94, 16
s_cbranch_scc1 L_W
s_sub_u32 s97, s94, 16
s_lshl_b32 s94, s97, 3
s_add_u32 s94, s94, s93
s_cmp_ge_u32 s3, 4
s_cbranch_scc1 L_A_ld
s_mov_b32 s18, 1152
s_mov_b32 s19, 0x20000
s_mov_b32 s10, 4718592
s_mov_b32 s11, 0x20000
v_lshlrev_b32 v108, 4, v1
v_lshlrev_b32 v109, 13, v3
v_lshl_add_u32 v109, v2, 4, v109
s_and_b32 s34, s97, 3
s_lshl_b32 s35, s93, 2
s_add_u32 s34, s34, s35
s_lshl_b32 s35, s34, 8
s_and_b32 s38, s97, 12
s_add_u32 s38, s38, s3
s_mul_i32 s36, s38, 294912
s_add_u32 s36, s36, s35
s_waitcnt lgkmcnt(0)
s_mov_b64 s[16:17], s[64:65]
s_mov_b64 s[8:9], s[68:69]
buffer_load_dwordx4 v[60:63], v108, s[16:19], 0 offen
buffer_load_dwordx4 v[64:67], v108, s[16:19], 0 offen offset:1024
buffer_load_dwordx4 v[68:71], v109, s[8:11], s36 offen nt
s_add_u32 s36, s36, 32768
buffer_load_dwordx4 v[72:75], v109, s[8:11], s36 offen nt
s_add_u32 s36, s36, 32768
buffer_load_dwordx4 v[76:79], v109, s[8:11], s36 offen nt
s_add_u32 s36, s36, 32768
buffer_load_dwordx4 v[80:83], v109, s[8:11], s36 offen nt
s_add_u32 s36, s36, 32768
buffer_load_dwordx4 v[84:87], v109, s[8:11], s36 offen nt
s_add_u32 s36, s36, 32768
buffer_load_dwordx4 v[88:91], v109, s[8:11], s36 offen nt
s_add_u32 s36, s36, 32768
buffer_load_dwordx4 v[92:95], v109, s[8:11], s36 offen nt
s_add_u32 s36, s36, 32768
buffer_load_dwordx4 v[96:99], v109, s[8:11], s36 offen nt
s_add_u32 s36, s36, 32768
buffer_load_dwordx4 v[100:103], v109, s[8:11], s36 offen nt
s_load_dword s92, s[90:91], 0
s_mov_b64 s[28:29], s[90:91]
v_and_b32 v250, 1, v0
v_lshlrev_b32 v250, 4, v250
v_mov_b32 v251, 0xffff
v_lshlrev_b32 v250, v250, v251
s_mov_b32 s32, 0x3030303
s_mov_b32 s33, 0x3030303
v_cndmask_b32 v4, 0, v250, s[32:33]
s_mov_b32 s32, 0xc0c0c0c
s_mov_b32 s33, 0xc0c0c0c
v_cndmask_b32 v5, 0, v250, s[32:33]
s_mov_b32 s32, 0x30303030
s_mov_b32 s33, 0x30303030
v_cndmask_b32 v6, 0, v250, s[32:33]
s_mov_b32 s32, 0xc0c0c0c0
s_mov_b32 s33, 0xc0c0c0c0
v_cndmask_b32 v7, 0, v250, s[32:33]
s_waitcnt lgkmcnt(0)
s_add_u32 s92, s92, 0x9e3779b9
v_lshlrev_b32 v110, 5, v2
v_lshl_add_u32 v110, v3, 4, v110
v_add_u32 v110, 147456, v110
s_lshl_b32 s35, s3, 9
v_add_u32 v111, s35, v110
v_lshlrev_b32 v109, 5, v2
v_lshl_add_u32 v109, v3, 4, v109
s_lshl_b32 s34, s34, 11
s_lshr_b32 s35, s97, 2
s_lshl_b32 s35, s35, 9
s_add_u32 s34, s34, s35
s_add_u32 s34, s34, 65536
v_mov_b32 v181, s92
v_mov_b32 v183, s92
s_lshl_b32 s36, s3, 7
s_add_u32 s36, s36, 131072
v_mov_b32 v104, s36
v_not_b32 v128, s92
v_not_b32 v129, s92
ds_write_b64 v104, v[128:129]
s_mul_i32 s36, s38, 144
s_add_u32 s36, s36, 143360
v_min_u32 v107, 8, v2
v_lshl_add_u32 v107, v107, 2, v3
v_lshl_add_u32 v107, v107, 2, s36
s_waitcnt vmcnt(9)
v_lshlrev_b32 v112, 16, v60
v_and_b32 v113, 0xffff0000, v60
v_lshlrev_b32 v114, 16, v61
v_and_b32 v115, 0xffff0000, v61
v_lshlrev_b32 v116, 16, v62
v_and_b32 v117, 0xffff0000, v62
v_lshlrev_b32 v118, 16, v63
v_and_b32 v119, 0xffff0000, v63
v_lshlrev_b32 v120, 16, v64
v_and_b32 v121, 0xffff0000, v64
v_lshlrev_b32 v122, 16, v65
v_and_b32 v123, 0xffff0000, v65
v_lshlrev_b32 v124, 16, v66
v_and_b32 v125, 0xffff0000, v66
v_lshlrev_b32 v126, 16, v67
v_and_b32 v127, 0xffff0000, v67
v_pk_add_f32 v[128:129], v[112:113], v[120:121]
v_pk_add_f32 v[130:131], v[114:115], v[122:123]
v_pk_add_f32 v[132:133], v[116:117], v[124:125]
v_pk_add_f32 v[134:135], v[118:119], v[126:127]
v_pk_add_f32 v[128:129], v[128:129], v[132:133]
v_pk_add_f32 v[130:131], v[130:131], v[134:135]
v_pk_add_f32 v[128:129], v[128:129], v[130:131]
v_add_f32 v128, v128, v129
s_nop 1
v_add_f32_dpp v128, v128, v128 row_ror:8 row_mask:0xf bank_mask:0xf
s_nop 1
v_add_f32_dpp v128, v128, v128 row_ror:4 row_mask:0xf bank_mask:0xf
s_nop 1
v_add_f32_dpp v128, v128, v128 row_ror:2 row_mask:0xf bank_mask:0xf
s_nop 1
v_add_f32_dpp v128, v128, v128 row_ror:1 row_mask:0xf bank_mask:0xf
s_nop 1
v_add_f32_dpp v128, v128, v128 row_bcast:15 row_mask:0xa bank_mask:0xf
s_nop 1
v_add_f32_dpp v128, v128, v128 row_bcast:31 row_mask:0xc bank_mask:0xf
s_nop 0
v_readlane_b32 s37, v128, 63
v_mov_b32 v128, 0x3ae38e39
s_nop 0
v_mul_f32 v128, s37, v128
v_cvt_pk_bf16_f32 v129, v128, v128
v_and_b32 v129, 0xffff0000, v129
v_sub_f32 v130, v112, v128
v_sub_f32 v131, v113, v128
v_sub_f32 v132, v114, v128
v_sub_f32 v133, v115, v128
v_sub_f32 v134, v116, v128
v_sub_f32 v135, v117, v128
v_sub_f32 v136, v118, v128
v_sub_f32 v137, v119, v128
v_mul_f32 v138, v130, v130
v_mul_f32 v139, v131, v131
v_fmac_f32 v138, v132, v132
v_fmac_f32 v139, v133, v133
v_fmac_f32 v138, v134, v134
v_fmac_f32 v139, v135, v135
v_fmac_f32 v138, v136, v136
v_fmac_f32 v139, v137, v137
s_mov_b32 exec_lo, 0xff
s_mov_b32 exec_hi, 0x0
v_sub_f32 v130, v120, v128
v_sub_f32 v131, v121, v128
v_sub_f32 v132, v122, v128
v_sub_f32 v133, v123, v128
v_sub_f32 v134, v124, v128
v_sub_f32 v135, v125, v128
v_sub_f32 v136, v126, v128
v_sub_f32 v137, v127, v128
v_fmac_f32 v138, v130, v130
v_fmac_f32 v139, v131, v131
v_fmac_f32 v138, v132, v132
v_fmac_f32 v139, v133, v133
v_fmac_f32 v138, v134, v134
v_fmac_f32 v139, v135, v135
v_fmac_f32 v138, v136, v136
v_fmac_f32 v139, v137, v137
s_mov_b64 exec, -1
v_add_f32 v138, v138, v139
v_sub_f32 v112, v112, v129
v_sub_f32 v113, v113, v129
v_add_f32_dpp v138, v138, v138 row_ror:8 row_mask:0xf bank_mask:0xf
v_sub_f32 v114, v114, v129
v_sub_f32 v115, v115, v129
v_add_f32_dpp v138, v138, v138 row_ror:4 row_mask:0xf bank_mask:0xf
v_sub_f32 v116, v116, v129
v_sub_f32 v117, v117, v129
v_add_f32_dpp v138, v138, v138 row_ror:2 row_mask:0xf bank_mask:0xf
v_sub_f32 v118, v118, v129
v_sub_f32 v119, v119, v129
v_add_f32_dpp v138, v138, v138 row_ror:1 row_mask:0xf bank_mask:0xf
v_sub_f32 v120, v120, v129
v_sub_f32 v121, v121, v129
v_add_f32_dpp v138, v138, v138 row_bcast:15 row_mask:0xa bank_mask:0xf
v_sub_f32 v122, v122, v129
v_sub_f32 v123, v123, v129
v_add_f32_dpp v138, v138, v138 row_bcast:31 row_mask:0xc bank_mask:0xf
v_sub_f32 v124, v124, v129
v_sub_f32 v125, v125, v129
v_sub_f32 v126, v126, v129
v_sub_f32 v127, v127, v129
v_readlane_b32 s37, v138, 63
v_mov_b32 v128, 0x3ae38e39
v_cvt_pk_bf16_f32 v130, v112, v113
v_cvt_pk_bf16_f32 v131, v114, v115
v_mul_f32 v128, s37, v128
v_cvt_pk_bf16_f32 v132, v116, v117
v_cvt_pk_bf16_f32 v128, v128, v128
v_cvt_pk_bf16_f32 v133, v118, v119
v_and_b32 v128, 0xffff0000, v128
v_cvt_pk_bf16_f32 v134, v120, v121
v_add_f32 v128, 0x3727c5ac, v128
v_cvt_pk_bf16_f32 v135, v122, v123
v_cvt_pk_bf16_f32 v128, v128, v128
v_cvt_pk_bf16_f32 v136, v124, v125
v_and_b32 v128, 0xffff0000, v128
v_cvt_pk_bf16_f32 v137, v126, v127
v_sqrt_f32 v128, v128
v_lshlrev_b32 v112, 16, v130
v_cvt_pk_bf16_f32 v128, v128, v128
v_and_b32 v113, 0xffff0000, v130
v_lshlrev_b32 v114, 16, v131
v_and_b32 v128, 0xffff0000, v128
v_and_b32 v115, 0xffff0000, v131
v_lshlrev_b32 v116, 16, v132
v_rcp_f32 v128, v128
v_and_b32 v117, 0xffff0000, v132
v_lshlrev_b32 v118, 16, v133
v_and_b32 v119, 0xffff0000, v133
v_lshlrev_b32 v120, 16, v134
v_and_b32 v121, 0xffff0000, v134
v_lshlrev_b32 v122, 16, v135
v_and_b32 v123, 0xffff0000, v135
v_lshlrev_b32 v124, 16, v136
v_and_b32 v125, 0xffff0000, v136
v_lshlrev_b32 v126, 16, v137
v_and_b32 v127, 0xffff0000, v137
v_mov_b32 v129, v128
v_pk_mul_f32 v[112:113], v[112:113], v[128:129]
v_pk_mul_f32 v[114:115], v[114:115], v[128:129]
v_pk_mul_f32 v[116:117], v[116:117], v[128:129]
v_pk_mul_f32 v[118:119], v[118:119], v[128:129]
v_pk_mul_f32 v[120:121], v[120:121], v[128:129]
v_pk_mul_f32 v[122:123], v[122:123], v[128:129]
v_pk_mul_f32 v[124:125], v[124:125], v[128:129]
v_pk_mul_f32 v[126:127], v[126:127], v[128:129]
v_lshlrev_b32 v108, 5, v1
v_add_u32 v108, 143360, v108
v_cvt_pk_bf16_f32 v112, v112, v112
v_cvt_pk_bf16_f32 v113, v113, v113
v_cvt_pk_bf16_f32 v114, v114, v114
v_cvt_pk_bf16_f32 v115, v115, v115
ds_write_b128 v108, v[112:115]
v_cvt_pk_bf16_f32 v116, v116, v116
v_cvt_pk_bf16_f32 v117, v117, v117
v_cvt_pk_bf16_f32 v118, v118, v118
v_cvt_pk_bf16_f32 v119, v119, v119
ds_write_b128 v108, v[116:119] offset:16
v_cvt_pk_bf16_f32 v120, v120, v120
v_cvt_pk_bf16_f32 v121, v121, v121
v_cvt_pk_bf16_f32 v122, v122, v122
v_cvt_pk_bf16_f32 v123, v123, v123
v_cvt_pk_bf16_f32 v124, v124, v124
v_cvt_pk_bf16_f32 v125, v125, v125
v_cvt_pk_bf16_f32 v126, v126, v126
v_cvt_pk_bf16_f32 v127, v127, v127
s_mov_b32 exec_lo, 0xff
s_mov_b32 exec_hi, 0x0
ds_write_b128 v108, v[120:123] offset:2048
ds_write_b128 v108, v[124:127] offset:2064
s_mov_b64 exec, -1
s_waitcnt lgkmcnt(0)
ds_read_b32 v128, v107
s_waitcnt lgkmcnt(0)
v_and_b32_dpp v140, v128, v4 row_newbcast:0 row_mask:0xf bank_mask:0xf
v_and_b32_dpp v141, v128, v5 row_newbcast:0 row_mask:0xf bank_mask:0xf
v_and_b32_dpp v142, v128, v6 row_newbcast:0 row_mask:0xf bank_mask:0xf
v_and_b32_dpp v143, v128, v7 row_newbcast:0 row_mask:0xf bank_mask:0xf
v_and_b32_dpp v144, v128, v4 row_newbcast:1 row_mask:0xf bank_mask:0xf
v_and_b32_dpp v145, v128, v5 row_newbcast:1 row_mask:0xf bank_mask:0xf
v_and_b32_dpp v146, v128, v6 row_newbcast:1 row_mask:0xf bank_mask:0xf
v_and_b32_dpp v147, v128, v7 row_newbcast:1 row_mask:0xf bank_mask:0xf
v_and_b32_dpp v148, v128, v4 row_newbcast:2 row_mask:0xf bank_mask:0xf
v_and_b32_dpp v149, v128, v5 row_newbcast:2 row_mask:0xf bank_mask:0xf
v_and_b32_dpp v150, v128, v6 row_newbcast:2 row_mask:0xf bank_mask:0xf
v_and_b32_dpp v151, v128, v7 row_newbcast:2 row_mask:0xf bank_mask:0xf
v_and_b32_dpp v152, v128, v4 row_newbcast:3 row_mask:0xf bank_mask:0xf
v_and_b32_dpp v153, v128, v5 row_newbcast:3 row_mask:0xf bank_mask:0xf
v_and_b32_dpp v154, v128, v6 row_newbcast:3 row_mask:0xf bank_mask:0xf
v_and_b32_dpp v155, v128, v7 row_newbcast:3 row_mask:0xf bank_mask:0xf
v_and_b32_dpp v156, v128, v4 row_newbcast:4 row_mask:0xf bank_mask:0xf
v_and_b32_dpp v157, v128, v5 row_newbcast:4 row_mask:0xf bank_mask:0xf
v_and_b32_dpp v158, v128, v6 row_newbcast:4 row_mask:0xf bank_mask:0xf
v_and_b32_dpp v159, v128, v7 row_newbcast:4 row_mask:0xf bank_mask:0xf
v_and_b32_dpp v160, v128, v4 row_newbcast:5 row_mask:0xf bank_mask:0xf
v_and_b32_dpp v161, v128, v5 row_newbcast:5 row_mask:0xf bank_mask:0xf
v_and_b32_dpp v162, v128, v6 row_newbcast:5 row_mask:0xf bank_mask:0xf
v_and_b32_dpp v163, v128, v7 row_newbcast:5 row_mask:0xf bank_mask:0xf
v_and_b32_dpp v164, v128, v4 row_newbcast:6 row_mask:0xf bank_mask:0xf
v_and_b32_dpp v165, v128, v5 row_newbcast:6 row_mask:0xf bank_mask:0xf
v_and_b32_dpp v166, v128, v6 row_newbcast:6 row_mask:0xf bank_mask:0xf
v_and_b32_dpp v167, v128, v7 row_newbcast:6 row_mask:0xf bank_mask:0xf
v_and_b32_dpp v168, v128, v4 row_newbcast:7 row_mask:0xf bank_mask:0xf
v_and_b32_dpp v169, v128, v5 row_newbcast:7 row_mask:0xf bank_mask:0xf
v_and_b32_dpp v170, v128, v6 row_newbcast:7 row_mask:0xf bank_mask:0xf
v_and_b32_dpp v171, v128, v7 row_newbcast:7 row_mask:0xf bank_mask:0xf
v_and_b32_dpp v172, v128, v4 row_newbcast:8 row_mask:0xf bank_mask:0xf
v_and_b32_dpp v173, v128, v5 row_newbcast:8 row_mask:0xf bank_mask:0xf
v_and_b32_dpp v174, v128, v6 row_newbcast:8 row_mask:0xf bank_mask:0xf
v_and_b32_dpp v175, v128, v7 row_newbcast:8 row_mask:0xf bank_mask:0xf
s_waitcnt vmcnt(8)
v_mfma_f32_16x16x32_bf16 v[176:179], v[140:143], v[68:71], 0
s_waitcnt vmcnt(7)
v_mfma_f32_16x16x32_bf16 v[176:179], v[144:147], v[72:75], v[176:179]
s_waitcnt vmcnt(6)
v_mfma_f32_16x16x32_bf16 v[176:179], v[148:151], v[76:79], v[176:179]
s_waitcnt vmcnt(5)
v_mfma_f32_16x16x32_bf16 v[176:179], v[152:155], v[80:83], v[176:179]
s_waitcnt vmcnt(4)
v_mfma_f32_16x16x32_bf16 v[176:179], v[156:159], v[84:87], v[176:179]
s_waitcnt vmcnt(3)
v_mfma_f32_16x16x32_bf16 v[176:179], v[160:163], v[88:91], v[176:179]
s_waitcnt vmcnt(2)
v_mfma_f32_16x16x32_bf16 v[176:179], v[164:167], v[92:95], v[176:179]
s_waitcnt vmcnt(1)
v_mfma_f32_16x16x32_bf16 v[176:179], v[168:171], v[96:99], v[176:179]
s_waitcnt vmcnt(0)
v_mfma_f32_16x16x32_bf16 v[176:179], v[172:175], v[100:103], v[176:179]
s_mov_b32 exec_lo, 0xffffffff
s_mov_b32 exec_hi, 0x0
s_nop 5
ds_write_b128 v111, v[176:179]
s_waitcnt lgkmcnt(0)
s_barrier
s_cmp_lg_u32 s3, 0
s_cbranch_scc1 L_q1s_1
ds_read_b128 v[72:75], v110 offset:512
ds_read_b128 v[76:79], v110 offset:1024
ds_read_b128 v[80:83], v110 offset:1536
s_waitcnt lgkmcnt(2)
v_pk_add_f32 v[176:177], v[176:177], v[72:73]
v_pk_add_f32 v[178:179], v[178:179], v[74:75]
s_waitcnt lgkmcnt(1)
v_pk_add_f32 v[176:177], v[176:177], v[76:77]
v_pk_add_f32 v[178:179], v[178:179], v[78:79]
s_waitcnt lgkmcnt(0)
v_pk_add_f32 v[176:177], v[176:177], v[80:81]
v_pk_add_f32 v[178:179], v[178:179], v[82:83]
v_cvt_pk_bf16_f32 v180, v176, v177
v_cvt_pk_bf16_f32 v182, v178, v179
buffer_store_dwordx4 v[180:183], v109, s[28:31], s34 offen sc1
L_q1s_1:
s_barrier
s_mov_b64 exec, -1
s_branch L_A_lo
L_A_ld:
s_mov_b32 s6, 16777216
s_mov_b32 s7, 0x20000
v_lshlrev_b32 v12, 4, v1
v_lshrrev_b32 v13, 3, v1
v_and_b32 v14, 7, v1
v_lshlrev_b32 v15, 17, v13
v_lshl_add_u32 v15, v14, 4, v15
s_lshr_b32 s41, s3, 2
s_lshl_b32 s41, s41, 16
s_lshl_b32 s32, s94, 9
s_add_u32 s41, s41, s32
s_and_b32 s32, s3, 3
s_lshl_b32 s32, s32, 7
s_add_u32 s41, s41, s32
s_add_u32 s41, s41, 1048576
v_lshrrev_b32 v16, 2, v1
v_lshlrev_b32 v16, 14, v16
v_and_b32 v27, 3, v1
v_lshrrev_b32 v23, 1, v16
v_lshl_add_u32 v23, v27, 3, v23
v_lshl_add_u32 v16, v27, 3, v16
s_lshl_b32 s43, s94, 6
s_add_u32 s43, s43, 819200
s_lshl_b32 s42, s94, 7
s_add_u32 s42, s42, 917504
s_sub_u32 s35, s3, 4
s_lshl_b32 s34, s35, 15
s_lshl_b32 s35, s35, 13
s_lshl_b32 s32, s94, 17
s_add_u32 s34, s34, s32
s_mov_b32 m0, s35
v_and_b32 v27, 1, v3
v_lshrrev_b32 v28, 1, v3
v_lshlrev_b32 v28, 3, v28
v_lshl_or_b32 v27, v27, 1, v28
v_xor_b32 v27, v27, v2
v_lshlrev_b32 v27, 4, v27
v_lshl_add_u32 v21, v3, 10, v27
s_waitcnt lgkmcnt(0)
s_mov_b64 s[4:5], s[66:67]
v_xor_b32 v17, 0, v21
buffer_load_dwordx4 v17, s[4:7], s34 offen nt lds
s_add_u32 m0, m0, 1024
s_add_u32 s34, s34, 4096
s_load_dword s92, s[90:91], 0
s_mov_b64 s[28:29], s[90:91]
s_waitcnt lgkmcnt(0)
s_add_u32 s92, s92, 0x9e3779b9
s_lshl_b32 s32, s3, 7
s_add_u32 s32, s32, 130560
v_mov_b32 v22, s32
v_mov_b32 v18, s92
v_mov_b32 v19, 0
v_and_b32 v24, 31, v1
v_lshrrev_b32 v25, 5, v1
v_bfe_u32 v27, v1, 2, 2
v_lshl_add_u32 v27, v25, 2, v27
v_and_b32 v28, 1, v1
v_lshlrev_b32 v28, 2, v28
v_bfe_u32 v29, v1, 4, 1
v_or_b32 v28, v28, v29
s_and_b32 s32, s3, 1
s_lshl_b32 s32, s32, 3
v_or_b32 v28, s32, v28
v_bfe_u32 v29, v1, 1, 1
s_lshr_b32 s32, s3, 1
s_lshl_b32 s32, s32, 15
v_lshl_add_u32 v29, v29, 3, s32
v_add_u32 v30, 0, v27
v_and_b32 v60, 1, v30
v_lshlrev_b32 v60, 1, v60
v_bfe_u32 v61, v30, 1, 1
v_lshl_or_b32 v60, v61, 3, v60
v_bfe_u32 v61, v30, 2, 1
v_or_b32 v60, v61, v60
v_bfe_u32 v61, v30, 3, 1
v_lshl_or_b32 v60, v61, 2, v60
v_lshl_add_u32 v30, v30, 8, v29
v_xor_b32 v61, 0, v28
v_xor_b32 v61, v61, v60
v_lshl_add_u32 v44, v61, 4, v30
v_xor_b32 v61, 2, v28
v_xor_b32 v61, v61, v60
v_lshl_add_u32 v45, v61, 4, v30
v_add_u32 v30, 8, v27
v_and_b32 v60, 1, v30
v_lshlrev_b32 v60, 1, v60
v_bfe_u32 v61, v30, 1, 1
v_lshl_or_b32 v60, v61, 3, v60
v_bfe_u32 v61, v30, 2, 1
v_or_b32 v60, v61, v60
v_bfe_u32 v61, v30, 3, 1
v_lshl_or_b32 v60, v61, 2, v60
v_lshl_add_u32 v30, v30, 8, v29
v_xor_b32 v61, 0, v28
v_xor_b32 v61, v61, v60
v_lshl_add_u32 v46, v61, 4, v30
v_xor_b32 v61, 2, v28
v_xor_b32 v61, v61, v60
v_lshl_add_u32 v47, v61, 4, v30
s_and_b32 s33, s3, 1
v_bfe_u32 v27, v24, 1, 1
v_xor_b32 v27, s33, v27
v_lshlrev_b32 v27, 7, v27
v_lshl_add_u32 v27, v24, 8, v27
v_add_u32 v27, s32, v27
v_lshlrev_b32 v28, 2, v25
v_and_b32 v29, 7, v24
v_xor_b32 v28, v28, v29
v_xor_b32 v29, 0, v28
v_lshl_add_u32 v52, v29, 4, v27
v_xor_b32 v29, 1, v28
v_lshl_add_u32 v53, v29, 4, v27
v_xor_b32 v29, 2, v28
v_lshl_add_u32 v54, v29, 4, v27
v_xor_b32 v29, 3, v28
v_lshl_add_u32 v55, v29, 4, v27
v_bfe_u32 v27, v13, 1, 1
v_xor_b32 v27, s33, v27
v_lshlrev_b32 v27, 7, v27
v_lshl_add_u32 v27, v13, 8, v27
v_add_u32 v27, s32, v27
v_xor_b32 v28, v13, v14
v_lshl_add_u32 v56, v28, 4, v27
v_mov_b32 v240, 0xfffefffe
v_add_u32 v57, 131072, v12
v_lshlrev_b32 v58, 4, v24
v_add_u32 v58, 139264, v58
v_mov_b32 v248, v58
s_barrier
s_barrier
v_xor_b32 v17, 16, v21
buffer_load_dwordx4 v17, s[4:7], s34 offen nt lds
s_add_u32 m0, m0, 1024
s_add_u32 s34, s34, 4096
v_xor_b32 v17, 64, v21
buffer_load_dwordx4 v17, s[4:7], s34 offen nt lds
s_add_u32 m0, m0, 1024
s_add_u32 s34, s34, 4096
v_xor_b32 v17, 80, v21
buffer_load_dwordx4 v17, s[4:7], s34 offen nt lds
s_add_u32 m0, m0, 1024
s_add_u32 s34, s34, 4096
ds_write_b32 v22, v18 offset:0
v_xor_b32 v17, 0, v21
buffer_load_dwordx4 v17, s[4:7], s34 offen nt lds
s_add_u32 m0, m0, 1024
s_add_u32 s34, s34, 4096
v_xor_b32 v17, 16, v21
buffer_load_dwordx4 v17, s[4:7], s34 offen nt lds
s_add_u32 m0, m0, 1024
s_add_u32 s34, s34, 4096
v_xor_b32 v17, 64, v21
buffer_load_dwordx4 v17, s[4:7], s34 offen nt lds
s_add_u32 m0, m0, 1024
s_add_u32 s34, s34, 4096
v_xor_b32 v17, 80, v21
buffer_load_dwordx4 v17, s[4:7], s34 offen nt lds
s_add_u32 m0, m0, 25600
s_sub_u32 s34, s34, 28416
v_xor_b32 v17, 0, v21
buffer_load_dwordx4 v17, s[4:7], s34 offen nt lds
s_add_u32 m0, m0, 1024
s_add_u32 s34, s34, 4096
v_xor_b32 v17, 16, v21
buffer_load_dwordx4 v17, s[4:7], s34 offen nt lds
s_add_u32 m0, m0, 1024
s_add_u32 s34, s34, 4096
v_xor_b32 v17, 64, v21
buffer_load_dwordx4 v17, s[4:7], s34 offen nt lds
s_add_u32 m0, m0, 1024
s_add_u32 s34, s34, 4096
v_xor_b32 v17, 80, v21
buffer_load_dwordx4 v17, s[4:7], s34 offen nt lds
s_add_u32 m0, m0, 1024
s_add_u32 s34, s34, 4096
v_xor_b32 v17, 0, v21
buffer_load_dwordx4 v17, s[4:7], s34 offen nt lds
s_add_u32 m0, m0, 1024
s_add_u32 s34, s34, 4096
v_xor_b32 v17, 16, v21
buffer_load_dwordx4 v17, s[4:7], s34 offen nt lds
s_add_u32 m0, m0, 1024
s_add_u32 s34, s34, 4096
s_waitcnt vmcnt(13)
v_xor_b32 v17, 64, v21
buffer_load_dwordx4 v17, s[4:7], s34 offen nt lds
s_add_u32 m0, m0, 1024
s_add_u32 s34, s34, 4096
s_waitcnt vmcnt(13)
v_xor_b32 v17, 80, v21
buffer_load_dwordx4 v17, s[4:7], s34 offen nt lds
s_add_u32 m0, m0, 25600
s_sub_u32 s34, s34, 28416
s_waitcnt vmcnt(13)
v_xor_b32 v17, 0, v21
buffer_load_dwordx4 v17, s[4:7], s34 offen nt lds
s_add_u32 m0, m0, 1024
s_add_u32 s34, s34, 4096
s_waitcnt vmcnt(13)
v_xor_b32 v17, 16, v21
buffer_load_dwordx4 v17, s[4:7], s34 offen nt lds
s_add_u32 m0, m0, 1024
s_add_u32 s34, s34, 4096
s_waitcnt vmcnt(13)
v_xor_b32 v17, 64, v21
buffer_load_dwordx4 v17, s[4:7], s34 offen nt lds
s_add_u32 m0, m0, 1024
s_add_u32 s34, s34, 4096
s_waitcnt vmcnt(13)
v_xor_b32 v17, 80, v21
buffer_load_dwordx4 v17, s[4:7], s34 offen nt lds
s_add_u32 m0, m0, 1024
s_add_u32 s34, s34, 4096
s_waitcnt vmcnt(13)
v_xor_b32 v17, 0, v21
buffer_load_dwordx4 v17, s[4:7], s34 offen nt lds
s_add_u32 m0, m0, 1024
s_add_u32 s34, s34, 4096
ds_write_b32 v22, v18 offset:4
s_waitcnt vmcnt(13)
v_xor_b32 v17, 16, v21
buffer_load_dwordx4 v17, s[4:7], s34 offen nt lds
s_add_u32 m0, m0, 1024
s_add_u32 s34, s34, 4096
s_waitcnt vmcnt(13)
v_xor_b32 v17, 64, v21
buffer_load_dwordx4 v17, s[4:7], s34 offen nt lds
s_add_u32 m0, m0, 1024
s_add_u32 s34, s34, 4096
s_waitcnt vmcnt(13)
v_xor_b32 v17, 80, v21
buffer_load_dwordx4 v17, s[4:7], s34 offen nt lds
s_add_u32 m0, m0, 25600
s_sub_u32 s34, s34, 28416
s_waitcnt vmcnt(13)
v_xor_b32 v17, 0, v21
buffer_load_dwordx4 v17, s[4:7], s34 offen nt lds
s_add_u32 m0, m0, 1024
s_add_u32 s34, s34, 4096
s_waitcnt vmcnt(13)
v_xor_b32 v17, 16, v21
buffer_load_dwordx4 v17, s[4:7], s34 offen nt lds
s_add_u32 m0, m0, 1024
s_add_u32 s34, s34, 4096
s_waitcnt vmcnt(13)
v_xor_b32 v17, 64, v21
buffer_load_dwordx4 v17, s[4:7], s34 offen nt lds
s_add_u32 m0, m0, 1024
s_add_u32 s34, s34, 4096
s_waitcnt vmcnt(13)
v_xor_b32 v17, 80, v21
buffer_load_dwordx4 v17, s[4:7], s34 offen nt lds
s_add_u32 m0, m0, 1024
s_add_u32 s34, s34, 4096
s_waitcnt vmcnt(13)
v_xor_b32 v17, 0, v21
buffer_load_dwordx4 v17, s[4:7], s34 offen nt lds
s_add_u32 m0, m0, 1024
s_add_u32 s34, s34, 4096
s_waitcnt vmcnt(13)
v_xor_b32 v17, 16, v21
buffer_load_dwordx4 v17, s[4:7], s34 offen nt lds
s_add_u32 m0, m0, 1024
s_add_u32 s34, s34, 4096
s_waitcnt vmcnt(13)
v_xor_b32 v17, 64, v21
buffer_load_dwordx4 v17, s[4:7], s34 offen nt lds
s_add_u32 m0, m0, 1024
s_add_u32 s34, s34, 4096
s_waitcnt vmcnt(13)
v_xor_b32 v17, 80, v21
buffer_load_dwordx4 v17, s[4:7], s34 offen nt lds
s_bfe_u32 s32, s92, 0x10001
s_bfe_u32 s33, s92, 0x10000
s_pack_ll_b32_b16 s4, s33, s32
s_bfe_u32 s32, s92, 0x10003
s_bfe_u32 s33, s92, 0x10002
s_pack_ll_b32_b16 s5, s33, s32
s_bfe_u32 s32, s92, 0x10005
s_bfe_u32 s33, s92, 0x10004
s_pack_ll_b32_b16 s6, s33, s32
s_bfe_u32 s32, s92, 0x10007
s_bfe_u32 s33, s92, 0x10006
s_pack_ll_b32_b16 s7, s33, s32
s_bfe_u32 s32, s92, 0x10009
s_bfe_u32 s33, s92, 0x10008
s_pack_ll_b32_b16 s8, s33, s32
s_bfe_u32 s32, s92, 0x1000b
s_bfe_u32 s33, s92, 0x1000a
s_pack_ll_b32_b16 s9, s33, s32
s_bfe_u32 s32, s92, 0x1000d
s_bfe_u32 s33, s92, 0x1000c
s_pack_ll_b32_b16 s10, s33, s32
s_bfe_u32 s32, s92, 0x1000f
s_bfe_u32 s33, s92, 0x1000e
s_pack_ll_b32_b16 s11, s33, s32
s_bfe_u32 s32, s92, 0x10011
s_bfe_u32 s33, s92, 0x10010
s_pack_ll_b32_b16 s12, s33, s32
s_bfe_u32 s32, s92, 0x10013
s_bfe_u32 s33, s92, 0x10012
s_pack_ll_b32_b16 s13, s33, s32
s_bfe_u32 s32, s92, 0x10015
s_bfe_u32 s33, s92, 0x10014
s_pack_ll_b32_b16 s14, s33, s32
s_bfe_u32 s32, s92, 0x10017
s_bfe_u32 s33, s92, 0x10016
s_pack_ll_b32_b16 s15, s33, s32
s_bfe_u32 s32, s92, 0x10019
s_bfe_u32 s33, s92, 0x10018
s_pack_ll_b32_b16 s16, s33, s32
s_bfe_u32 s32, s92, 0x1001b
s_bfe_u32 s33, s92, 0x1001a
s_pack_ll_b32_b16 s17, s33, s32
s_bfe_u32 s32, s92, 0x1001d
s_bfe_u32 s33, s92, 0x1001c
s_pack_ll_b32_b16 s18, s33, s32
s_bfe_u32 s32, s92, 0x1001f
s_bfe_u32 s33, s92, 0x1001e
s_pack_ll_b32_b16 s19, s33, s32
s_mov_b32 s39, 0x07060302
s_barrier
s_waitcnt vmcnt(13)
s_waitcnt vmcnt(12)
s_waitcnt vmcnt(11)
s_waitcnt vmcnt(10)
s_waitcnt vmcnt(9)
s_waitcnt vmcnt(8)
s_barrier
s_waitcnt vmcnt(7)
s_waitcnt vmcnt(6)
s_waitcnt vmcnt(5)
s_waitcnt vmcnt(4)
s_waitcnt vmcnt(3)
s_waitcnt vmcnt(2)
s_waitcnt vmcnt(1)
s_waitcnt vmcnt(0)
s_barrier
s_branch L_A_hi
L_A_lo:
v_lshlrev_b32 v12, 4, v1
v_lshrrev_b32 v13, 3, v1
v_and_b32 v14, 7, v1
v_lshlrev_b32 v15, 17, v13
v_lshl_add_u32 v15, v14, 4, v15
s_lshr_b32 s41, s3, 2
s_lshl_b32 s41, s41, 16
s_lshl_b32 s32, s94, 9
s_add_u32 s41, s41, s32
s_and_b32 s32, s3, 3
s_lshl_b32 s32, s32, 7
s_add_u32 s41, s41, s32
s_add_u32 s41, s41, 1048576
v_lshlrev_b32 v20, 7, v14
v_add_u32 v20, 4096, v20
v_mov_b32 v18, s92
v_mov_b32 v19, 0
v_and_b32 v24, 31, v1
v_lshrrev_b32 v25, 5, v1
v_lshlrev_b32 v22, 10, v13
v_lshl_add_u32 v22, v14, 4, v22
s_lshl_b32 s36, s3, 13
s_add_u32 s36, s36, 393216
v_xor_b32 v23, v13, v14
v_lshlrev_b32 v23, 4, v23
v_lshrrev_b32 v27, 1, v14
v_lshl_add_u32 v23, v27, 10, v23
v_and_b32 v27, 1, v14
v_lshl_add_u32 v23, v27, 9, v23
s_lshl_b32 s32, s3, 7
s_add_u32 s32, s32, 131072
v_add_u32 v23, s32, v23
v_lshrrev_b32 v23, 1, v1
v_lshlrev_b32 v23, 10, v23
v_and_b32 v27, 1, v1
v_lshl_add_u32 v23, v27, 9, v23
v_lshl_add_u32 v23, v14, 4, v23
v_add_u32 v23, s32, v23
v_xor_b32 v96, 0, v23
v_xor_b32 v97, 16, v23
v_xor_b32 v98, 32, v23
v_xor_b32 v99, 48, v23
v_xor_b32 v100, 64, v23
v_xor_b32 v101, 80, v23
v_xor_b32 v102, 96, v23
v_xor_b32 v103, 112, v23
s_add_u32 s37, s36, 4096
v_and_b32 v26, 1, v24
v_lshlrev_b32 v26, 1, v26
v_bfe_u32 v27, v24, 1, 1
v_lshl_or_b32 v26, v27, 3, v26
v_bfe_u32 v27, v24, 2, 1
v_or_b32 v26, v27, v26
v_bfe_u32 v27, v24, 3, 1
v_lshl_or_b32 v26, v27, 2, v26
s_mul_i32 s32, s3, 8192
v_lshl_add_u32 v27, v24, 8, s32
v_xor_b32 v28, v25, v26
v_xor_b32 v29, 0, v28
v_lshl_add_u32 v32, v29, 4, v27
v_xor_b32 v29, 2, v28
v_lshl_add_u32 v33, v29, 4, v27
v_xor_b32 v29, 4, v28
v_lshl_add_u32 v34, v29, 4, v27
v_xor_b32 v29, 6, v28
v_lshl_add_u32 v35, v29, 4, v27
v_xor_b32 v29, 8, v28
v_lshl_add_u32 v36, v29, 4, v27
v_xor_b32 v29, 10, v28
v_lshl_add_u32 v37, v29, 4, v27
v_xor_b32 v29, 12, v28
v_lshl_add_u32 v38, v29, 4, v27
v_xor_b32 v29, 14, v28
v_lshl_add_u32 v39, v29, 4, v27
v_lshlrev_b32 v27, 9, v25
v_add_u32 v27, 131072, v27
v_xor_b32 v28, v25, v24
v_xor_b32 v29, 0, v28
v_lshl_add_u32 v40, v29, 4, v27
v_xor_b32 v29, 2, v28
v_lshl_add_u32 v41, v29, 4, v27
v_xor_b32 v29, 4, v28
v_lshl_add_u32 v42, v29, 4, v27
v_xor_b32 v29, 6, v28
v_lshl_add_u32 v43, v29, 4, v27
v_bfe_u32 v27, v1, 2, 2
v_lshl_add_u32 v27, v25, 2, v27
v_and_b32 v28, 1, v1
v_lshlrev_b32 v28, 2, v28
v_bfe_u32 v29, v1, 4, 1
v_or_b32 v28, v28, v29
s_and_b32 s32, s3, 1
s_lshl_b32 s32, s32, 3
v_or_b32 v28, s32, v28
v_bfe_u32 v29, v1, 1, 1
s_lshr_b32 s32, s3, 1
s_lshl_b32 s32, s32, 15
v_lshl_add_u32 v29, v29, 3, s32
v_add_u32 v30, 0, v27
v_and_b32 v60, 1, v30
v_lshlrev_b32 v60, 1, v60
v_bfe_u32 v61, v30, 1, 1
v_lshl_or_b32 v60, v61, 3, v60
v_bfe_u32 v61, v30, 2, 1
v_or_b32 v60, v61, v60
v_bfe_u32 v61, v30, 3, 1
v_lshl_or_b32 v60, v61, 2, v60
v_lshl_add_u32 v30, v30, 8, v29
v_xor_b32 v61, 0, v28
v_xor_b32 v61, v61, v60
v_lshl_add_u32 v44, v61, 4, v30
v_xor_b32 v61, 2, v28
v_xor_b32 v61, v61, v60
v_lshl_add_u32 v45, v61, 4, v30
v_add_u32 v30, 8, v27
v_and_b32 v60, 1, v30
v_lshlrev_b32 v60, 1, v60
v_bfe_u32 v61, v30, 1, 1
v_lshl_or_b32 v60, v61, 3, v60
v_bfe_u32 v61, v30, 2, 1
v_or_b32 v60, v61, v60
v_bfe_u32 v61, v30, 3, 1
v_lshl_or_b32 v60, v61, 2, v60
v_lshl_add_u32 v30, v30, 8, v29
v_xor_b32 v61, 0, v28
v_xor_b32 v61, v61, v60
v_lshl_add_u32 v46, v61, 4, v30
v_xor_b32 v61, 2, v28
v_xor_b32 v61, v61, v60
v_lshl_add_u32 v47, v61, 4, v30
s_and_b32 s33, s3, 1
v_bfe_u32 v27, v24, 1, 1
v_xor_b32 v27, s33, v27
v_lshlrev_b32 v27, 7, v27
v_lshl_add_u32 v27, v24, 8, v27
v_add_u32 v27, s32, v27
v_lshlrev_b32 v28, 2, v25
v_and_b32 v29, 7, v24
v_xor_b32 v28, v28, v29
v_xor_b32 v29, 0, v28
v_lshl_add_u32 v52, v29, 4, v27
v_xor_b32 v29, 1, v28
v_lshl_add_u32 v53, v29, 4, v27
v_xor_b32 v29, 2, v28
v_lshl_add_u32 v54, v29, 4, v27
v_xor_b32 v29, 3, v28
v_lshl_add_u32 v55, v29, 4, v27
v_bfe_u32 v27, v13, 1, 1
v_xor_b32 v27, s33, v27
v_lshlrev_b32 v27, 7, v27
v_lshl_add_u32 v27, v13, 8, v27
v_add_u32 v27, s32, v27
v_xor_b32 v28, v13, v14
v_lshl_add_u32 v56, v28, 4, v27
v_mov_b32 v240, 0xfffefffe
v_add_u32 v57, 131072, v12
v_lshlrev_b32 v58, 4, v24
v_add_u32 v58, 139264, v58
v_mov_b32 v248, v58
s_lshl_b32 s33, s3, 2
v_add_u32 v249, s33, v248
v_add_u32 v59, s33, v58
s_lshl_b32 s32, s3, 11
v_add_u32 v60, s32, v57
s_bfe_u32 s32, s92, 0x10001
s_bfe_u32 s33, s92, 0x10000
s_pack_ll_b32_b16 s4, s33, s32
s_bfe_u32 s32, s92, 0x10003
s_bfe_u32 s33, s92, 0x10002
s_pack_ll_b32_b16 s5, s33, s32
s_bfe_u32 s32, s92, 0x10005
s_bfe_u32 s33, s92, 0x10004
s_pack_ll_b32_b16 s6, s33, s32
s_bfe_u32 s32, s92, 0x10007
s_bfe_u32 s33, s92, 0x10006
s_pack_ll_b32_b16 s7, s33, s32
s_bfe_u32 s32, s92, 0x10009
s_bfe_u32 s33, s92, 0x10008
s_pack_ll_b32_b16 s8, s33, s32
s_bfe_u32 s32, s92, 0x1000b
s_bfe_u32 s33, s92, 0x1000a
s_pack_ll_b32_b16 s9, s33, s32
s_bfe_u32 s32, s92, 0x1000d
s_bfe_u32 s33, s92, 0x1000c
s_pack_ll_b32_b16 s10, s33, s32
s_bfe_u32 s32, s92, 0x1000f
s_bfe_u32 s33, s92, 0x1000e
s_pack_ll_b32_b16 s11, s33, s32
s_bfe_u32 s32, s92, 0x10011
s_bfe_u32 s33, s92, 0x10010
s_pack_ll_b32_b16 s12, s33, s32
s_bfe_u32 s32, s92, 0x10013
s_bfe_u32 s33, s92, 0x10012
s_pack_ll_b32_b16 s13, s33, s32
s_bfe_u32 s32, s92, 0x10015
s_bfe_u32 s33, s92, 0x10014
s_pack_ll_b32_b16 s14, s33, s32
s_bfe_u32 s32, s92, 0x10017
s_bfe_u32 s33, s92, 0x10016
s_pack_ll_b32_b16 s15, s33, s32
s_bfe_u32 s32, s92, 0x10019
s_bfe_u32 s33, s92, 0x10018
s_pack_ll_b32_b16 s16, s33, s32
s_bfe_u32 s32, s92, 0x1001b
s_bfe_u32 s33, s92, 0x1001a
s_pack_ll_b32_b16 s17, s33, s32
s_bfe_u32 s32, s92, 0x1001d
s_bfe_u32 s33, s92, 0x1001c
s_pack_ll_b32_b16 s18, s33, s32
s_bfe_u32 s32, s92, 0x1001f
s_bfe_u32 s33, s92, 0x1001e
s_pack_ll_b32_b16 s19, s33, s32
s_mov_b32 s39, 0x07060302
s_lshl_b32 s32, s3, 7
s_add_u32 s32, s32, 131072
v_mov_b32 v62, s32
L_mka_2:
ds_read_b32 v63, v62 offset:0
s_waitcnt lgkmcnt(0)
v_cmp_ne_u32 vcc, s92, v63
s_nop 0
s_cbranch_vccz L_mko_3
s_cmp_eq_u32 s95, 0
s_cbranch_scc1 L_mko_3
s_sub_u32 s95, s95, 1
s_branch L_mka_2
L_mko_3:
L_fqa_4:
buffer_load_dword v21, v20, s[28:31], 0 offen sc1
s_waitcnt vmcnt(0)
v_cmp_ne_u32 vcc, s92, v21
s_nop 0
s_cbranch_vccz L_fqo_5
s_cmp_eq_u32 s95, 0
s_cbranch_scc1 L_fqo_5
s_sub_u32 s95, s95, 1
s_branch L_fqa_4
L_fqo_5:
L_mka_6:
ds_read_b32 v63, v62 offset:4
s_waitcnt lgkmcnt(0)
v_cmp_ne_u32 vcc, s92, v63
s_nop 0
s_cbranch_vccz L_mko_7
s_cmp_eq_u32 s95, 0
s_cbranch_scc1 L_mko_7
s_sub_u32 s95, s95, 1
s_branch L_mka_6
L_mko_7:
s_mov_b32 s38, 0xff
buffer_load_dwordx4 v[64:67], v12, s[28:31], s36 offen offset:0 sc1
buffer_load_dwordx4 v[68:71], v12, s[28:31], s36 offen offset:1024 sc1
buffer_load_dwordx4 v[72:75], v12, s[28:31], s36 offen offset:2048 sc1
buffer_load_dwordx4 v[76:79], v12, s[28:31], s36 offen offset:3072 sc1
buffer_load_dwordx4 v[80:83], v12, s[28:31], s37 offen offset:0 sc1
buffer_load_dwordx4 v[84:87], v12, s[28:31], s37 offen offset:1024 sc1
buffer_load_dwordx4 v[88:91], v12, s[28:31], s37 offen offset:2048 sc1
buffer_load_dwordx4 v[92:95], v12, s[28:31], s37 offen offset:3072 sc1
s_waitcnt vmcnt(7)
v_max3_u32 v27, v64, v65, v66
v_max_u32 v27, v27, v67
v_cmp_eq_u32 vcc, -1, v27
s_nop 0
s_cbranch_vccnz L_qn_11
ds_write_b128 v96, v[64:67]
s_bitset0_b32 s38, 0
L_qn_11:
s_waitcnt vmcnt(6)
v_max3_u32 v27, v68, v69, v70
v_max_u32 v27, v27, v71
v_cmp_eq_u32 vcc, -1, v27
s_nop 0
s_cbranch_vccnz L_qn_12
ds_write_b128 v97, v[68:71]
s_bitset0_b32 s38, 1
L_qn_12:
s_waitcnt vmcnt(5)
v_max3_u32 v27, v72, v73, v74
v_max_u32 v27, v27, v75
v_cmp_eq_u32 vcc, -1, v27
s_nop 0
s_cbranch_vccnz L_qn_13
ds_write_b128 v98, v[72:75]
s_bitset0_b32 s38, 2
L_qn_13:
s_waitcnt vmcnt(4)
v_max3_u32 v27, v76, v77, v78
v_max_u32 v27, v27, v79
v_cmp_eq_u32 vcc, -1, v27
s_nop 0
s_cbranch_vccnz L_qn_14
ds_write_b128 v99, v[76:79]
s_bitset0_b32 s38, 3
L_qn_14:
s_waitcnt vmcnt(3)
v_max3_u32 v27, v80, v81, v82
v_max_u32 v27, v27, v83
v_cmp_eq_u32 vcc, -1, v27
s_nop 0
s_cbranch_vccnz L_qn_15
ds_write_b128 v100, v[80:83]
s_bitset0_b32 s38, 4
L_qn_15:
s_waitcnt vmcnt(2)
v_max3_u32 v27, v84, v85, v86
v_max_u32 v27, v27, v87
v_cmp_eq_u32 vcc, -1, v27
s_nop 0
s_cbranch_vccnz L_qn_16
ds_write_b128 v101, v[84:87]
s_bitset0_b32 s38, 5
L_qn_16:
s_waitcnt vmcnt(1)
v_max3_u32 v27, v88, v89, v90
v_max_u32 v27, v27, v91
v_cmp_eq_u32 vcc, -1, v27
s_nop 0
s_cbranch_vccnz L_qn_17
ds_write_b128 v102, v[88:91]
s_bitset0_b32 s38, 6
L_qn_17:
s_waitcnt vmcnt(0)
v_max3_u32 v27, v92, v93, v94
v_max_u32 v27, v27, v95
v_cmp_eq_u32 vcc, -1, v27
s_nop 0
s_cbranch_vccnz L_qn_18
ds_write_b128 v103, v[92:95]
s_bitset0_b32 s38, 7
L_qn_18:
s_cmp_eq_u32 s38, 0
s_cbranch_scc1 L_qao_9
L_qaa_8:
s_bitcmp1_b32 s38, 0
s_cbranch_scc0 L_qn_19
buffer_load_dwordx4 v[64:67], v12, s[28:31], s36 offen offset:0 sc1
L_qn_19:
s_bitcmp1_b32 s38, 1
s_cbranch_scc0 L_qn_20
buffer_load_dwordx4 v[68:71], v12, s[28:31], s36 offen offset:1024 sc1
L_qn_20:
s_bitcmp1_b32 s38, 2
s_cbranch_scc0 L_qn_21
buffer_load_dwordx4 v[72:75], v12, s[28:31], s36 offen offset:2048 sc1
L_qn_21:
s_bitcmp1_b32 s38, 3
s_cbranch_scc0 L_qn_22
buffer_load_dwordx4 v[76:79], v12, s[28:31], s36 offen offset:3072 sc1
L_qn_22:
s_bitcmp1_b32 s38, 4
s_cbranch_scc0 L_qn_23
buffer_load_dwordx4 v[80:83], v12, s[28:31], s37 offen offset:0 sc1
L_qn_23:
s_bitcmp1_b32 s38, 5
s_cbranch_scc0 L_qn_24
buffer_load_dwordx4 v[84:87], v12, s[28:31], s37 offen offset:1024 sc1
L_qn_24:
s_bitcmp1_b32 s38, 6
s_cbranch_scc0 L_qn_25
buffer_load_dwordx4 v[88:91], v12, s[28:31], s37 offen offset:2048 sc1
L_qn_25:
s_bitcmp1_b32 s38, 7
s_cbranch_scc0 L_qn_26
buffer_load_dwordx4 v[92:95], v12, s[28:31], s37 offen offset:3072 sc1
L_qn_26:
s_waitcnt vmcnt(0)
s_cmp_eq_u32 s95, 0
s_cselect_b64 s[32:33], 0, -1
s_bitcmp1_b32 s38, 0
s_cbranch_scc0 L_qn_27
v_max3_u32 v27, v64, v65, v66
v_max_u32 v27, v27, v67
v_cmp_eq_u32 vcc, -1, v27
s_nop 0
s_and_b64 vcc, vcc, s[32:33]
s_cbranch_vccnz L_qn_27
ds_write_b128 v96, v[64:67]
s_bitset0_b32 s38, 0
L_qn_27:
s_bitcmp1_b32 s38, 1
s_cbranch_scc0 L_qn_28
v_max3_u32 v27, v68, v69, v70
v_max_u32 v27, v27, v71
v_cmp_eq_u32 vcc, -1, v27
s_nop 0
s_and_b64 vcc, vcc, s[32:33]
s_cbranch_vccnz L_qn_28
ds_write_b128 v97, v[68:71]
s_bitset0_b32 s38, 1
L_qn_28:
s_bitcmp1_b32 s38, 2
s_cbranch_scc0 L_qn_29
v_max3_u32 v27, v72, v73, v74
v_max_u32 v27, v27, v75
v_cmp_eq_u32 vcc, -1, v27
s_nop 0
s_and_b64 vcc, vcc, s[32:33]
s_cbranch_vccnz L_qn_29
ds_write_b128 v98, v[72:75]
s_bitset0_b32 s38, 2
L_qn_29:
s_bitcmp1_b32 s38, 3
s_cbranch_scc0 L_qn_30
v_max3_u32 v27, v76, v77, v78
v_max_u32 v27, v27, v79
v_cmp_eq_u32 vcc, -1, v27
s_nop 0
s_and_b64 vcc, vcc, s[32:33]
s_cbranch_vccnz L_qn_30
ds_write_b128 v99, v[76:79]
s_bitset0_b32 s38, 3
L_qn_30:
s_bitcmp1_b32 s38, 4
s_cbranch_scc0 L_qn_31
v_max3_u32 v27, v80, v81, v82
v_max_u32 v27, v27, v83
v_cmp_eq_u32 vcc, -1, v27
s_nop 0
s_and_b64 vcc, vcc, s[32:33]
s_cbranch_vccnz L_qn_31
ds_write_b128 v100, v[80:83]
s_bitset0_b32 s38, 4
L_qn_31:
s_bitcmp1_b32 s38, 5
s_cbranch_scc0 L_qn_32
v_max3_u32 v27, v84, v85, v86
v_max_u32 v27, v27, v87
v_cmp_eq_u32 vcc, -1, v27
s_nop 0
s_and_b64 vcc, vcc, s[32:33]
s_cbranch_vccnz L_qn_32
ds_write_b128 v101, v[84:87]
s_bitset0_b32 s38, 5
L_qn_32:
s_bitcmp1_b32 s38, 6
s_cbranch_scc0 L_qn_33
v_max3_u32 v27, v88, v89, v90
v_max_u32 v27, v27, v91
v_cmp_eq_u32 vcc, -1, v27
s_nop 0
s_and_b64 vcc, vcc, s[32:33]
s_cbranch_vccnz L_qn_33
ds_write_b128 v102, v[88:91]
s_bitset0_b32 s38, 6
L_qn_33:
s_bitcmp1_b32 s38, 7
s_cbranch_scc0 L_qn_34
v_max3_u32 v27, v92, v93, v94
v_max_u32 v27, v27, v95
v_cmp_eq_u32 vcc, -1, v27
s_nop 0
s_and_b64 vcc, vcc, s[32:33]
s_cbranch_vccnz L_qn_34
ds_write_b128 v103, v[92:95]
s_bitset0_b32 s38, 7
L_qn_34:
s_sub_u32 s95, s95, 1
s_max_i32 s95, s95, 0
s_cmp_lg_u32 s38, 0
s_cbranch_scc1 L_qaa_8
L_qao_9:
s_waitcnt lgkmcnt(0)
s_barrier
ds_read_b128 v[176:179], v40 offset:0
ds_read_b128 v[80:83], v32 offset:0
ds_read_b128 v[180:183], v41 offset:1024
ds_read_b128 v[84:87], v33 offset:0
ds_read_b128 v[184:187], v42 offset:2048
ds_read_b128 v[88:91], v34 offset:0
ds_read_b128 v[188:191], v43 offset:3072
ds_read_b128 v[92:95], v35 offset:0
s_waitcnt lgkmcnt(6)
v_mfma_f32_32x32x16_bf16 v[64:79], v[80:83], v[176:179], 0
ds_read_b128 v[192:195], v40 offset:4096
ds_read_b128 v[96:99], v36 offset:0
s_waitcnt lgkmcnt(6)
v_mfma_f32_32x32x16_bf16 v[64:79], v[84:87], v[180:183], v[64:79]
ds_read_b128 v[196:199], v41 offset:5120
ds_read_b128 v[100:103], v37 offset:0
s_waitcnt lgkmcnt(6)
v_mfma_f32_32x32x16_bf16 v[64:79], v[88:91], v[184:187], v[64:79]
ds_read_b128 v[200:203], v42 offset:6144
ds_read_b128 v[104:107], v38 offset:0
s_waitcnt lgkmcnt(6)
v_mfma_f32_32x32x16_bf16 v[64:79], v[92:95], v[188:191], v[64:79]
ds_read_b128 v[204:207], v43 offset:7168
ds_read_b128 v[108:111], v39 offset:0
s_waitcnt lgkmcnt(6)
v_mfma_f32_32x32x16_bf16 v[64:79], v[96:99], v[192:195], v[64:79]
ds_read_b128 v[176:179], v40 offset:8192
ds_read_b128 v[80:83], v32 offset:32768
v_add_u32 v32, 0x10000, v32
s_waitcnt lgkmcnt(6)
v_mfma_f32_32x32x16_bf16 v[64:79], v[100:103], v[196:199], v[64:79]
ds_read_b128 v[180:183], v41 offset:9216
ds_read_b128 v[84:87], v33 offset:32768
v_add_u32 v33, 0x10000, v33
s_waitcnt lgkmcnt(6)
v_mfma_f32_32x32x16_bf16 v[64:79], v[104:107], v[200:203], v[64:79]
ds_read_b128 v[184:187], v42 offset:10240
ds_read_b128 v[88:91], v34 offset:32768
v_add_u32 v34, 0x10000, v34
s_waitcnt lgkmcnt(6)
v_mfma_f32_32x32x16_bf16 v[64:79], v[108:111], v[204:207], v[64:79]
ds_read_b128 v[188:191], v43 offset:11264
ds_read_b128 v[92:95], v35 offset:32768
v_add_u32 v35, 0x10000, v35
s_waitcnt lgkmcnt(6)
v_mfma_f32_32x32x16_bf16 v[64:79], v[80:83], v[176:179], v[64:79]
ds_read_b128 v[192:195], v40 offset:12288
ds_read_b128 v[96:99], v36 offset:32768
v_add_u32 v36, 0x10000, v36
s_waitcnt lgkmcnt(6)
v_mfma_f32_32x32x16_bf16 v[64:79], v[84:87], v[180:183], v[64:79]
ds_read_b128 v[196:199], v41 offset:13312
ds_read_b128 v[100:103], v37 offset:32768
v_add_u32 v37, 0x10000, v37
s_waitcnt lgkmcnt(6)
v_mfma_f32_32x32x16_bf16 v[64:79], v[88:91], v[184:187], v[64:79]
ds_read_b128 v[200:203], v42 offset:14336
ds_read_b128 v[104:107], v38 offset:32768
v_add_u32 v38, 0x10000, v38
s_waitcnt lgkmcnt(6)
v_mfma_f32_32x32x16_bf16 v[64:79], v[92:95], v[188:191], v[64:79]
ds_read_b128 v[204:207], v43 offset:15360
ds_read_b128 v[108:111], v39 offset:32768
v_add_u32 v39, 0x10000, v39
s_waitcnt lgkmcnt(6)
v_mfma_f32_32x32x16_bf16 v[64:79], v[96:99], v[192:195], v[64:79]
s_barrier
ds_read_b128 v[176:179], v40 offset:16384
ds_read_b128 v[80:83], v32 offset:0
s_waitcnt lgkmcnt(6)
v_mfma_f32_32x32x16_bf16 v[64:79], v[100:103], v[196:199], v[64:79]
ds_read_b128 v[180:183], v41 offset:17408
ds_read_b128 v[84:87], v33 offset:0
s_waitcnt lgkmcnt(6)
v_mfma_f32_32x32x16_bf16 v[64:79], v[104:107], v[200:203], v[64:79]
ds_read_b128 v[184:187], v42 offset:18432
ds_read_b128 v[88:91], v34 offset:0
s_waitcnt lgkmcnt(6)
v_mfma_f32_32x32x16_bf16 v[64:79], v[108:111], v[204:207], v[64:79]
ds_read_b128 v[188:191], v43 offset:19456
ds_read_b128 v[92:95], v35 offset:0
s_waitcnt lgkmcnt(6)
v_mfma_f32_32x32x16_bf16 v[64:79], v[80:83], v[176:179], v[64:79]
ds_read_b128 v[192:195], v40 offset:20480
ds_read_b128 v[96:99], v36 offset:0
s_waitcnt lgkmcnt(6)
v_mfma_f32_32x32x16_bf16 v[64:79], v[84:87], v[180:183], v[64:79]
ds_read_b128 v[196:199], v41 offset:21504
ds_read_b128 v[100:103], v37 offset:0
s_waitcnt lgkmcnt(6)
v_mfma_f32_32x32x16_bf16 v[64:79], v[88:91], v[184:187], v[64:79]
ds_read_b128 v[200:203], v42 offset:22528
ds_read_b128 v[104:107], v38 offset:0
s_waitcnt lgkmcnt(6)
v_mfma_f32_32x32x16_bf16 v[64:79], v[92:95], v[188:191], v[64:79]
ds_read_b128 v[204:207], v43 offset:23552
ds_read_b128 v[108:111], v39 offset:0
s_waitcnt lgkmcnt(6)
v_mfma_f32_32x32x16_bf16 v[64:79], v[96:99], v[192:195], v[64:79]
s_barrier
ds_read_b128 v[176:179], v40 offset:24576
ds_read_b128 v[80:83], v32 offset:32768
s_waitcnt lgkmcnt(6)
v_mfma_f32_32x32x16_bf16 v[64:79], v[100:103], v[196:199], v[64:79]
ds_read_b128 v[180:183], v41 offset:25600
ds_read_b128 v[84:87], v33 offset:32768
s_waitcnt lgkmcnt(6)
v_mfma_f32_32x32x16_bf16 v[64:79], v[104:107], v[200:203], v[64:79]
ds_read_b128 v[184:187], v42 offset:26624
ds_read_b128 v[88:91], v34 offset:32768
s_waitcnt lgkmcnt(6)
v_mfma_f32_32x32x16_bf16 v[64:79], v[108:111], v[204:207], v[64:79]
ds_read_b128 v[188:191], v43 offset:27648
ds_read_b128 v[92:95], v35 offset:32768
s_waitcnt lgkmcnt(6)
v_mfma_f32_32x32x16_bf16 v[64:79], v[80:83], v[176:179], v[64:79]
ds_read_b128 v[192:195], v40 offset:28672
ds_read_b128 v[96:99], v36 offset:32768
s_waitcnt lgkmcnt(6)
v_mfma_f32_32x32x16_bf16 v[64:79], v[84:87], v[180:183], v[64:79]
ds_read_b128 v[196:199], v41 offset:29696
ds_read_b128 v[100:103], v37 offset:32768
s_waitcnt lgkmcnt(6)
v_mfma_f32_32x32x16_bf16 v[64:79], v[88:91], v[184:187], v[64:79]
ds_read_b128 v[200:203], v42 offset:30720
ds_read_b128 v[104:107], v38 offset:32768
s_waitcnt lgkmcnt(6)
v_mfma_f32_32x32x16_bf16 v[64:79], v[92:95], v[188:191], v[64:79]
ds_read_b128 v[204:207], v43 offset:31744
ds_read_b128 v[108:111], v39 offset:32768
s_waitcnt lgkmcnt(6)
v_mfma_f32_32x32x16_bf16 v[64:79], v[96:99], v[192:195], v[64:79]
ds_read_b64_tr_b16 v[112:113], v44 offset:0
ds_read_b64_tr_b16 v[114:115], v46 offset:0
ds_read_b64_tr_b16 v[116:117], v44 offset:4096
ds_read_b64_tr_b16 v[118:119], v46 offset:4096
s_waitcnt lgkmcnt(8)
v_mfma_f32_32x32x16_bf16 v[64:79], v[100:103], v[196:199], v[64:79]
ds_read_b64_tr_b16 v[120:121], v44 offset:8192
ds_read_b64_tr_b16 v[122:123], v46 offset:8192
ds_read_b64_tr_b16 v[124:125], v44 offset:12288
ds_read_b64_tr_b16 v[126:127], v46 offset:12288
s_waitcnt lgkmcnt(10)
v_mfma_f32_32x32x16_bf16 v[64:79], v[104:107], v[200:203], v[64:79]
ds_read_b64_tr_b16 v[128:129], v44 offset:16384
ds_read_b64_tr_b16 v[130:131], v46 offset:16384
ds_read_b64_tr_b16 v[132:133], v44 offset:20480
ds_read_b64_tr_b16 v[134:135], v46 offset:20480
s_waitcnt lgkmcnt(12)
v_mfma_f32_32x32x16_bf16 v[64:79], v[108:111], v[204:207], v[64:79]
ds_read_b64_tr_b16 v[136:137], v44 offset:24576
ds_read_b64_tr_b16 v[138:139], v46 offset:24576
ds_read_b64_tr_b16 v[140:141], v44 offset:28672
ds_read_b64_tr_b16 v[142:143], v46 offset:28672
ds_read_b64_tr_b16 v[144:145], v45 offset:0
ds_read_b64_tr_b16 v[146:147], v47 offset:0
ds_read_b64_tr_b16 v[148:149], v45 offset:4096
ds_read_b64_tr_b16 v[150:151], v47 offset:4096
ds_read_b64_tr_b16 v[152:153], v45 offset:8192
ds_read_b64_tr_b16 v[154:155], v47 offset:8192
ds_read_b64_tr_b16 v[156:157], v45 offset:12288
ds_read_b64_tr_b16 v[158:159], v47 offset:12288
v_max3_f32 v27, v64, v65, v66
v_max3_f32 v28, v67, v68, v69
v_max3_f32 v27, v27, v70, v71
v_max3_f32 v28, v28, v72, v73
v_max3_f32 v27, v27, v74, v75
v_max3_f32 v28, v28, v76, v77
v_max3_f32 v27, v27, v78, v79
v_max_f32 v27, v27, v28
v_mov_b32 v28, v27
s_nop 1
v_permlane32_swap_b32 v27, v28
v_max_f32 v27, v27, v28
ds_write_b32 v59, v27
s_waitcnt lgkmcnt(0)
s_barrier
ds_read_b128 v[28:31], v58
s_waitcnt lgkmcnt(0)
v_max3_f32 v26, v28, v29, v30
v_max_f32 v26, v26, v31
v_mov_b32 v27, v26
v_pk_add_f32 v[64:65], v[64:65], v[26:27] neg_lo:[0,1] neg_hi:[0,1]
v_pk_add_f32 v[66:67], v[66:67], v[26:27] neg_lo:[0,1] neg_hi:[0,1]
v_pk_add_f32 v[68:69], v[68:69], v[26:27] neg_lo:[0,1] neg_hi:[0,1]
v_pk_add_f32 v[70:71], v[70:71], v[26:27] neg_lo:[0,1] neg_hi:[0,1]
v_exp_f32 v64, v64
ds_read_b64_tr_b16 v[160:161], v45 offset:16384
v_exp_f32 v65, v65
ds_read_b64_tr_b16 v[162:163], v47 offset:16384
v_exp_f32 v66, v66
ds_read_b64_tr_b16 v[164:165], v45 offset:20480
v_cvt_pk_bf16_f32 v80, v64, v65
v_exp_f32 v67, v67
ds_read_b64_tr_b16 v[166:167], v47 offset:20480
v_exp_f32 v68, v68
ds_read_b64_tr_b16 v[168:169], v45 offset:24576
v_cvt_pk_bf16_f32 v81, v66, v67
v_exp_f32 v69, v69
ds_read_b64_tr_b16 v[170:171], v47 offset:24576
v_exp_f32 v70, v70
ds_read_b64_tr_b16 v[172:173], v45 offset:28672
v_cvt_pk_bf16_f32 v82, v68, v69
v_exp_f32 v71, v71
ds_read_b64_tr_b16 v[174:175], v47 offset:28672
v_pk_add_f32 v[64:65], v[64:65], v[66:67]
v_cvt_pk_bf16_f32 v83, v70, v71
ds_write_b128 v60, v[80:83] offset:0
v_pk_add_f32 v[72:73], v[72:73], v[26:27] neg_lo:[0,1] neg_hi:[0,1]
v_pk_add_f32 v[74:75], v[74:75], v[26:27] neg_lo:[0,1] neg_hi:[0,1]
v_pk_add_f32 v[76:77], v[76:77], v[26:27] neg_lo:[0,1] neg_hi:[0,1]
v_pk_add_f32 v[78:79], v[78:79], v[26:27] neg_lo:[0,1] neg_hi:[0,1]
v_exp_f32 v72, v72
v_exp_f32 v73, v73
v_exp_f32 v74, v74
v_cvt_pk_bf16_f32 v84, v72, v73
v_exp_f32 v75, v75
v_exp_f32 v76, v76
v_cvt_pk_bf16_f32 v85, v74, v75
v_exp_f32 v77, v77
v_exp_f32 v78, v78
v_cvt_pk_bf16_f32 v86, v76, v77
v_exp_f32 v79, v79
v_pk_add_f32 v[72:73], v[72:73], v[74:75]
v_cvt_pk_bf16_f32 v87, v78, v79
ds_write_b128 v60, v[84:87] offset:1024
v_pk_add_f32 v[68:69], v[68:69], v[70:71]
v_pk_add_f32 v[76:77], v[76:77], v[78:79]
v_pk_add_f32 v[64:65], v[64:65], v[72:73]
v_pk_add_f32 v[68:69], v[68:69], v[76:77]
v_pk_add_f32 v[64:65], v[64:65], v[68:69]
v_add_f32 v64, v64, v65
v_mov_b32 v28, v64
s_nop 1
v_permlane32_swap_b32 v64, v28
v_add_f32 v28, v64, v28
ds_write_b32 v249, v28 offset:512
s_waitcnt lgkmcnt(0)
s_barrier
s_branch L_A_pv
L_A_hi:
s_barrier
ds_read_b64_tr_b16 v[112:113], v44 offset:0
ds_read_b64_tr_b16 v[114:115], v46 offset:0
ds_read_b64_tr_b16 v[116:117], v44 offset:4096
ds_read_b64_tr_b16 v[118:119], v46 offset:4096
ds_read_b64_tr_b16 v[120:121], v44 offset:8192
ds_read_b64_tr_b16 v[122:123], v46 offset:8192
ds_read_b64_tr_b16 v[124:125], v44 offset:12288
ds_read_b64_tr_b16 v[126:127], v46 offset:12288
ds_read_b64_tr_b16 v[128:129], v44 offset:16384
ds_read_b64_tr_b16 v[130:131], v46 offset:16384
ds_read_b64_tr_b16 v[132:133], v44 offset:20480
ds_read_b64_tr_b16 v[134:135], v46 offset:20480
ds_read_b64_tr_b16 v[136:137], v44 offset:24576
ds_read_b64_tr_b16 v[138:139], v46 offset:24576
ds_read_b64_tr_b16 v[140:141], v44 offset:28672
ds_read_b64_tr_b16 v[142:143], v46 offset:28672
ds_read_b64_tr_b16 v[144:145], v45 offset:0
ds_read_b64_tr_b16 v[146:147], v47 offset:0
ds_read_b64_tr_b16 v[148:149], v45 offset:4096
ds_read_b64_tr_b16 v[150:151], v47 offset:4096
ds_read_b64_tr_b16 v[152:153], v45 offset:8192
ds_read_b64_tr_b16 v[154:155], v47 offset:8192
ds_read_b64_tr_b16 v[156:157], v45 offset:12288
ds_read_b64_tr_b16 v[158:159], v47 offset:12288
ds_read_b64_tr_b16 v[160:161], v45 offset:16384
ds_read_b64_tr_b16 v[162:163], v47 offset:16384
ds_read_b64_tr_b16 v[164:165], v45 offset:20480
ds_read_b64_tr_b16 v[166:167], v47 offset:20480
ds_read_b64_tr_b16 v[168:169], v45 offset:24576
ds_read_b64_tr_b16 v[170:171], v47 offset:24576
ds_read_b64_tr_b16 v[172:173], v45 offset:28672
ds_read_b64_tr_b16 v[174:175], v47 offset:28672
s_cmp_lg_u32 s3, 4
s_cbranch_scc1 L_nom_35
ds_read_b128 v[64:67], v58
v_mov_b32 v73, v18
s_waitcnt lgkmcnt(0)
v_max3_f32 v72, v64, v65, v66
v_max_f32 v72, v72, v67
s_mov_b32 exec_lo, 0xffffffff
s_mov_b32 exec_hi, 0x0
buffer_store_dwordx2 v[72:73], v16, s[28:31], s42 offen sc1
s_mov_b64 exec, -1
L_nom_35:
s_waitcnt lgkmcnt(0)
s_barrier
s_cmp_lg_u32 s3, 4
s_cbranch_scc1 L_A_pv
ds_read_b128 v[68:71], v248 offset:512
v_mov_b32 v75, v18
s_waitcnt lgkmcnt(0)
v_add_f32 v68, v68, v69
v_add_f32 v70, v70, v71
v_add_f32 v74, v68, v70
s_mov_b32 exec_lo, 0xffffffff
s_mov_b32 exec_hi, 0x0
buffer_store_dwordx2 v[74:75], v23, s[28:31], s43 offen sc1
s_mov_b64 exec, -1
L_A_pv:
ds_read_b128 v[80:83], v57 offset:0
ds_read_b128 v[84:87], v57 offset:1024
ds_read_b128 v[88:91], v57 offset:2048
ds_read_b128 v[92:95], v57 offset:3072
ds_read_b128 v[96:99], v57 offset:4096
ds_read_b128 v[100:103], v57 offset:5120
ds_read_b128 v[104:107], v57 offset:6144
ds_read_b128 v[108:111], v57 offset:7168
s_waitcnt lgkmcnt(7)
v_mfma_f32_32x32x16_bf16 v[176:191], v[112:115], v[80:83], 0
s_waitcnt lgkmcnt(6)
v_mfma_f32_32x32x16_bf16 v[176:191], v[116:119], v[84:87], v[176:191]
s_waitcnt lgkmcnt(5)
v_mfma_f32_32x32x16_bf16 v[176:191], v[120:123], v[88:91], v[176:191]
s_waitcnt lgkmcnt(4)
v_mfma_f32_32x32x16_bf16 v[176:191], v[124:127], v[92:95], v[176:191]
s_waitcnt lgkmcnt(3)
v_mfma_f32_32x32x16_bf16 v[176:191], v[128:131], v[96:99], v[176:191]
s_waitcnt lgkmcnt(2)
v_mfma_f32_32x32x16_bf16 v[176:191], v[132:135], v[100:103], v[176:191]
s_waitcnt lgkmcnt(1)
v_mfma_f32_32x32x16_bf16 v[176:191], v[136:139], v[104:107], v[176:191]
s_waitcnt lgkmcnt(0)
v_mfma_f32_32x32x16_bf16 v[176:191], v[140:143], v[108:111], v[176:191]
v_mfma_f32_32x32x16_bf16 v[192:207], v[144:147], v[80:83], 0
v_mfma_f32_32x32x16_bf16 v[192:207], v[148:151], v[84:87], v[192:207]
s_nop 9
v_perm_b32 v208, v177, v176, s39
v_perm_b32 v209, v179, v178, s39
v_perm_b32 v210, v181, v180, s39
v_perm_b32 v211, v183, v182, s39
v_mfma_f32_32x32x16_bf16 v[192:207], v[152:155], v[88:91], v[192:207]
v_add_u32 v208, 0x10001, v208
v_add_u32 v209, 0x10001, v209
v_add_u32 v210, 0x10001, v210
v_add_u32 v211, 0x10001, v211
v_mfma_f32_32x32x16_bf16 v[192:207], v[156:159], v[92:95], v[192:207]
v_and_or_b32 v208, v208, v240, s4
v_and_or_b32 v209, v209, v240, s5
v_and_or_b32 v210, v210, v240, s6
v_and_or_b32 v211, v211, v240, s7
v_mfma_f32_32x32x16_bf16 v[192:207], v[160:163], v[96:99], v[192:207]
ds_write_b128 v52, v[208:211]
v_perm_b32 v212, v185, v184, s39
v_perm_b32 v213, v187, v186, s39
v_perm_b32 v214, v189, v188, s39
v_mfma_f32_32x32x16_bf16 v[192:207], v[164:167], v[100:103], v[192:207]
v_perm_b32 v215, v191, v190, s39
v_add_u32 v212, 0x10001, v212
v_add_u32 v213, 0x10001, v213
v_add_u32 v214, 0x10001, v214
v_mfma_f32_32x32x16_bf16 v[192:207], v[168:171], v[104:107], v[192:207]
v_add_u32 v215, 0x10001, v215
v_and_or_b32 v212, v212, v240, s8
v_and_or_b32 v213, v213, v240, s9
v_and_or_b32 v214, v214, v240, s10
v_mfma_f32_32x32x16_bf16 v[192:207], v[172:175], v[108:111], v[192:207]
v_and_or_b32 v215, v215, v240, s11
ds_write_b128 v53, v[212:215]
s_nop 9
v_perm_b32 v216, v193, v192, s39
v_perm_b32 v217, v195, v194, s39
v_perm_b32 v218, v197, v196, s39
v_perm_b32 v219, v199, v198, s39
v_add_u32 v216, 0x10001, v216
v_add_u32 v217, 0x10001, v217
v_add_u32 v218, 0x10001, v218
v_add_u32 v219, 0x10001, v219
v_and_or_b32 v216, v216, v240, s12
v_and_or_b32 v217, v217, v240, s13
v_and_or_b32 v218, v218, v240, s14
v_and_or_b32 v219, v219, v240, s15
ds_write_b128 v54, v[216:219]
v_perm_b32 v220, v201, v200, s39
v_perm_b32 v221, v203, v202, s39
v_perm_b32 v222, v205, v204, s39
v_perm_b32 v223, v207, v206, s39
v_add_u32 v220, 0x10001, v220
v_add_u32 v221, 0x10001, v221
v_add_u32 v222, 0x10001, v222
v_add_u32 v223, 0x10001, v223
v_and_or_b32 v220, v220, v240, s16
v_and_or_b32 v221, v221, v240, s17
v_and_or_b32 v222, v222, v240, s18
v_and_or_b32 v223, v223, v240, s19
ds_write_b128 v55, v[220:223]
s_waitcnt lgkmcnt(0)
ds_read_b128 v[224:227], v56 offset:0
ds_read_b128 v[228:231], v56 offset:2048
ds_read_b128 v[232:235], v56 offset:4096
ds_read_b128 v[236:239], v56 offset:6144
s_waitcnt lgkmcnt(3)
buffer_store_dwordx4 v[224:227], v15, s[28:31], s41 offen sc1
s_add_u32 s41, s41, 0x100000
s_waitcnt lgkmcnt(2)
buffer_store_dwordx4 v[228:231], v15, s[28:31], s41 offen sc1
s_add_u32 s41, s41, 0x100000
s_waitcnt lgkmcnt(1)
buffer_store_dwordx4 v[232:235], v15, s[28:31], s41 offen sc1
s_add_u32 s41, s41, 0x100000
s_waitcnt lgkmcnt(0)
buffer_store_dwordx4 v[236:239], v15, s[28:31], s41 offen sc1
s_cmp_ge_u32 s94, 18
s_cbranch_scc1 L_A_end
s_barrier
s_cmp_ge_u32 s3, 2
s_cbranch_scc1 L_A_end
s_mov_b32 s8, s64
s_mov_b32 s9, s65
s_mov_b32 s10, 1152
s_mov_b32 s11, 0x20000
s_mov_b32 s12, s84
s_mov_b32 s13, s85
s_mov_b32 s14, 1152
s_mov_b32 s15, 0x20000
s_mov_b32 s16, s86
s_mov_b32 s17, s87
s_mov_b32 s18, 1152
s_mov_b32 s19, 0x20000
v_lshlrev_b32 v20, 2, v14
v_add_u32 v20, v20, v3
v_lshlrev_b32 v20, 1, v20
s_lshl_b32 s34, s94, 6
buffer_load_ushort v21, v20, s[8:11], s34 offen
buffer_load_ushort v22, v20, s[12:15], s34 offen
v_lshlrev_b32 v25, 2, v1
v_add_u32 v25, 143360, v25
s_lshl_b32 s35, s94, 13
s_mul_i32 s36, s3, 147456
s_add_u32 s36, s36, s35
s_add_u32 s36, s36, 524288
s_add_u32 s37, s36, 4096
v_lshlrev_b32 v27, 2, v1
v_add_u32 v27, 8192, v27
buffer_load_dword v26, v27, s[28:31], 0 offen sc1
s_waitcnt vmcnt(0)
s_branch L_flc_38
L_fla_36:
buffer_load_dword v26, v27, s[28:31], 0 offen sc1
s_waitcnt vmcnt(0)
L_flc_38:
v_cmp_ne_u32 vcc, s92, v26
s_nop 0
s_cbranch_vccz L_flo_37
s_cmp_eq_u32 s95, 0
s_cbranch_scc1 L_flo_37
s_sub_u32 s95, s95, 1
s_branch L_fla_36
L_flo_37:
L_ga_39:
buffer_load_dwordx4 v[64:67], v12, s[28:31], s36 offen offset:0 sc1
buffer_load_dwordx4 v[68:71], v12, s[28:31], s36 offen offset:1024 sc1
buffer_load_dwordx4 v[72:75], v12, s[28:31], s36 offen offset:2048 sc1
buffer_load_dwordx4 v[76:79], v12, s[28:31], s36 offen offset:3072 sc1
buffer_load_dwordx4 v[80:83], v12, s[28:31], s37 offen offset:0 sc1
buffer_load_dwordx4 v[84:87], v12, s[28:31], s37 offen offset:1024 sc1
buffer_load_dwordx4 v[88:91], v12, s[28:31], s37 offen offset:2048 sc1
buffer_load_dwordx4 v[92:95], v12, s[28:31], s37 offen offset:3072 sc1
s_waitcnt vmcnt(6)
v_max3_u32 v27, v64, v65, v66
v_max_u32 v28, v67, v67
v_max3_u32 v27, v68, v69, v27
v_max3_u32 v28, v70, v71, v28
v_pk_add_f32 v[64:65], v[64:65], v[68:69]
v_pk_add_f32 v[66:67], v[66:67], v[70:71]
s_waitcnt vmcnt(4)
v_max3_u32 v27, v72, v73, v27
v_max3_u32 v28, v74, v75, v28
v_max3_u32 v27, v76, v77, v27
v_max3_u32 v28, v78, v79, v28
v_pk_add_f32 v[72:73], v[72:73], v[76:77]
v_pk_add_f32 v[74:75], v[74:75], v[78:79]
v_pk_add_f32 v[64:65], v[64:65], v[72:73]
v_pk_add_f32 v[66:67], v[66:67], v[74:75]
s_waitcnt vmcnt(2)
v_max3_u32 v27, v80, v81, v27
v_max3_u32 v28, v82, v83, v28
v_max3_u32 v27, v84, v85, v27
v_max3_u32 v28, v86, v87, v28
v_pk_add_f32 v[80:81], v[80:81], v[84:85]
v_pk_add_f32 v[82:83], v[82:83], v[86:87]
v_pk_add_f32 v[64:65], v[64:65], v[80:81]
v_pk_add_f32 v[66:67], v[66:67], v[82:83]
s_waitcnt vmcnt(0)
v_max3_u32 v27, v88, v89, v27
v_max3_u32 v28, v90, v91, v28
v_max3_u32 v27, v92, v93, v27
v_max3_u32 v28, v94, v95, v28
v_pk_add_f32 v[88:89], v[88:89], v[92:93]
v_pk_add_f32 v[90:91], v[90:91], v[94:95]
v_pk_add_f32 v[64:65], v[64:65], v[88:89]
v_pk_add_f32 v[66:67], v[66:67], v[90:91]
v_max_u32 v27, v27, v28
v_cmp_eq_u32 vcc, -1, v27
s_nop 0
s_cbranch_vccz L_go_40
s_cmp_eq_u32 s95, 0
s_cbranch_scc1 L_go_40
s_sub_u32 s95, s95, 1
s_branch L_ga_39
L_go_40:
v_add_f32_dpp v64, v64, v64 row_ror:8 row_mask:0xf bank_mask:0xf
v_add_f32_dpp v65, v65, v65 row_ror:8 row_mask:0xf bank_mask:0xf
v_add_f32_dpp v66, v66, v66 row_ror:8 row_mask:0xf bank_mask:0xf
v_add_f32_dpp v67, v67, v67 row_ror:8 row_mask:0xf bank_mask:0xf
v_permlane16_swap_b32 v64, v65
s_nop 0
v_permlane16_swap_b32 v66, v67
v_add_f32 v64, v64, v65
v_add_f32 v66, v66, v67
s_nop 1
v_permlane32_swap_b32 v64, v66
v_add_f32 v24, v64, v66
s_cmp_eq_u32 s3, 0
s_cbranch_scc1 L_A_fin
v_lshlrev_b32 v22, 16, v22
v_cvt_pk_bf16_f32 v23, v24, v24
v_and_b32 v23, 0xffff0000, v23
v_add_f32 v23, v23, v22
v_cvt_pk_bf16_f32 v23, v23, v23
v_and_b32 v23, 0xffff0000, v23
v_mul_f32 v24, 0xbfb8aa3b, v23
v_exp_f32 v24, v24
s_nop 0
v_add_f32 v24, 1.0, v24
v_rcp_f32 v24, v24
s_nop 0
v_mul_f32 v23, v23, v24
v_cvt_pk_bf16_f32 v23, v23, v23
v_and_b32 v23, 0xffff0000, v23
ds_write_b32 v25, v23
s_waitcnt lgkmcnt(0)
s_barrier
s_branch L_A_end
L_A_fin:
s_barrier
ds_read_b32 v23, v25
v_lshlrev_b32 v21, 16, v21
v_cvt_pk_bf16_f32 v24, v24, v24
v_and_b32 v24, 0xffff0000, v24
s_waitcnt lgkmcnt(0)
v_mul_f32 v24, v24, v23
v_cvt_pk_bf16_f32 v24, v24, v24
v_and_b32 v24, 0xffff0000, v24
v_add_f32 v24, v24, v21
v_cvt_pk_bf16_f32 v24, v24, v24
s_mov_b32 exec_lo, 0xff00ff
s_mov_b32 exec_hi, 0xff00ff
buffer_store_short v24, v20, s[16:19], s34 offen
s_cmp_lg_u32 s94, 0
s_cbranch_scc1 L_A_end
s_mov_b32 exec_lo, 0x1
s_mov_b32 exec_hi, 0x0
buffer_store_dword v18, v19, s[28:31], 0 offen offset:0
L_A_end:
s_endpgm
L_W:
s_waitcnt lgkmcnt(0)
s_load_dword s92, s[90:91], 0
s_mov_b64 s[28:29], s[90:91]
s_cmp_ge_u32 s94, 8
s_cbranch_scc1 L_F
s_and_b32 s34, s94, 7
s_lshl_b32 s40, s93, 3
s_add_u32 s40, s40, s34
v_mov_b32 v8, -1
v_mov_b32 v9, -1
v_mov_b32 v10, -1
v_mov_b32 v11, -1
v_lshlrev_b32 v12, 4, v1
s_cmp_lg_u32 s3, 7
s_cbranch_scc1 L_nc_41
s_cmp_lg_u32 s34, 0
s_cbranch_scc1 L_nc_42
s_lshl_b32 s32, s93, 12
s_add_u32 s32, s32, 393216
buffer_store_dwordx4 v[8:11], v12, s[28:31], s32 offen offset:0 sc1
buffer_store_dwordx4 v[8:11], v12, s[28:31], s32 offen offset:1024 sc1
buffer_store_dwordx4 v[8:11], v12, s[28:31], s32 offen offset:2048 sc1
buffer_store_dwordx4 v[8:11], v12, s[28:31], s32 offen offset:3072 sc1
s_waitcnt lgkmcnt(0)
s_add_u32 s33, s92, 0x9e3779b9
v_mov_b32 v14, s33
v_mov_b32 v13, 0
s_lshl_b32 s32, s93, 7
s_add_u32 s32, s32, 4096
s_waitcnt vmcnt(0)
s_mov_b32 exec_lo, 0x1
s_mov_b32 exec_hi, 0x0
buffer_store_dword v14, v13, s[28:31], s32 offen sc1
s_mov_b64 exec, -1
s_branch L_nc_42
L_nc_41:
s_sub_u32 s33, s3, 1
s_cmp_ge_u32 s33, 5
s_cbranch_scc1 L_nc_42
s_mul_i32 s32, s40, 5
s_add_u32 s32, s32, s33
s_cmp_ge_u32 s32, 288
s_cbranch_scc1 L_nc_42
s_lshl_b32 s32, s32, 10
s_add_u32 s32, s32, 524288
buffer_store_dwordx4 v[8:11], v12, s[28:31], s32 offen sc1
L_nc_42:
s_mov_b32 s8, s72
s_mov_b32 s9, s73
s_mov_b32 s10, 4194304
s_mov_b32 s11, 0x20000
s_mov_b32 s12, s74
s_mov_b32 s13, s75
s_mov_b32 s14, 4718592
s_mov_b32 s15, 0x20000
s_and_b32 s34, s94, 3
s_lshl_b32 s35, s93, 2
s_add_u32 s34, s34, s35
s_lshr_b32 s35, s94, 2
s_lshl_b32 s40, s93, 3
s_add_u32 s40, s40, s94
v_lshlrev_b32 v8, 1, v3
v_xor_b32 v8, v8, v2
v_lshlrev_b32 v8, 4, v8
v_lshl_add_u32 v8, v3, 13, v8
v_xor_b32 v9, 0x80, v8
s_lshl_b32 s36, s35, 3
s_add_u32 s36, s36, s3
s_lshl_b32 s36, s36, 18
s_lshl_b32 s37, s34, 8
s_add_u32 s36, s36, s37
v_and_b32 v250, 1, v0
v_lshlrev_b32 v250, 4, v250
v_mov_b32 v251, 0xffff
v_lshlrev_b32 v250, v250, v251
s_mov_b32 s32, 0x3030303
s_mov_b32 s33, 0x3030303
v_cndmask_b32 v4, 0, v250, s[32:33]
s_mov_b32 s32, 0xc0c0c0c
s_mov_b32 s33, 0xc0c0c0c
v_cndmask_b32 v5, 0, v250, s[32:33]
s_mov_b32 s32, 0x30303030
s_mov_b32 s33, 0x30303030
v_cndmask_b32 v6, 0, v250, s[32:33]
s_mov_b32 s32, 0xc0c0c0c0
s_mov_b32 s33, 0xc0c0c0c0
v_cndmask_b32 v7, 0, v250, s[32:33]
s_waitcnt lgkmcnt(0)
s_add_u32 s92, s92, 0x9e3779b9
s_waitcnt vmcnt(0)
s_barrier
s_cmp_lg_u32 s3, 0
s_cbranch_scc1 L_nofl_43
s_lshl_b32 s32, s40, 2
s_add_u32 s32, s32, 8192
v_mov_b32 v12, s92
v_mov_b32 v13, 0
s_mov_b32 exec_lo, 0x1
s_mov_b32 exec_hi, 0x0
buffer_store_dword v12, v13, s[28:31], s32 offen sc1
s_mov_b64 exec, -1
L_nofl_43:
s_lshl_b32 s37, s3, 13
s_add_u32 m0, s37, 98304
s_nop 0
buffer_load_dwordx4 v8, s[8:11], s36 offen nt lds
s_add_u32 m0, m0, 1024
s_add_u32 s36, s36, 32768
buffer_load_dwordx4 v8, s[8:11], s36 offen nt lds
s_add_u32 m0, m0, 1024
s_add_u32 s36, s36, 32768
buffer_load_dwordx4 v9, s[8:11], s36 offen nt lds
s_add_u32 m0, m0, 1024
s_add_u32 s36, s36, 32768
s_waitcnt vmcnt(2)
buffer_load_dwordx4 v9, s[8:11], s36 offen nt lds
s_add_u32 m0, m0, 1024
s_add_u32 s36, s36, 32768
s_waitcnt vmcnt(2)
buffer_load_dwordx4 v8, s[8:11], s36 offen nt lds
s_add_u32 m0, m0, 1024
s_add_u32 s36, s36, 32768
s_waitcnt vmcnt(2)
buffer_load_dwordx4 v8, s[8:11], s36 offen nt lds
s_add_u32 m0, m0, 1024
s_add_u32 s36, s36, 32768
s_waitcnt vmcnt(2)
buffer_load_dwordx4 v9, s[8:11], s36 offen nt lds
s_add_u32 m0, m0, 1024
s_add_u32 s36, s36, 32768
s_waitcnt vmcnt(2)
buffer_load_dwordx4 v9, s[8:11], s36 offen nt lds
v_bfe_u32 v240, v1, 2, 2
v_and_b32 v241, 1, v3
v_lshl_or_b32 v240, v241, 2, v240
v_lshrrev_b32 v241, 1, v3
v_lshl_or_b32 v240, v241, 4, v240
v_mul_u32_u24 v240, 1184, v240
v_and_b32 v241, 3, v1
v_lshl_add_u32 v240, v241, 3, v240
s_lshl_b32 s37, s3, 6
s_add_u32 s37, s37, 5120
v_add_u32 v244, s37, v240
v_add_u32 v245, 75776, v244
s_lshl_b32 s37, s3, 7
s_add_u32 s37, s37, 4096
v_add_u32 v240, s37, v240
v_add_u32 v241, 75776, v240
v_lshlrev_b32 v10, 4, v1
s_lshl_b32 s36, s34, 7
s_add_u32 s36, s36, s3
s_mul_i32 s36, s36, 1152
s_mul_i32 s37, s3, 1184
s_add_u32 m0, s37, 4096
s_waitcnt vmcnt(2)
buffer_load_dwordx4 v10, s[12:15], s36 offen nt lds
s_mov_b32 exec_lo, 0xff
s_mov_b32 exec_hi, 0x0
buffer_load_dwordx4 v10, s[12:15], s36 offen offset:1024 nt lds
s_mov_b64 exec, -1
s_add_u32 m0, m0, 9472
s_add_u32 s36, s36, 9216
s_waitcnt vmcnt(4)
buffer_load_dwordx4 v10, s[12:15], s36 offen nt lds
s_mov_b32 exec_lo, 0xff
s_mov_b32 exec_hi, 0x0
buffer_load_dwordx4 v10, s[12:15], s36 offen offset:1024 nt lds
s_mov_b64 exec, -1
s_add_u32 m0, m0, 9472
s_add_u32 s36, s36, 9216
s_waitcnt vmcnt(4)
buffer_load_dwordx4 v10, s[12:15], s36 offen nt lds
s_mov_b32 exec_lo, 0xff
s_mov_b32 exec_hi, 0x0
buffer_load_dwordx4 v10, s[12:15], s36 offen offset:1024 nt lds
s_mov_b64 exec, -1
s_add_u32 m0, m0, 9472
s_add_u32 s36, s36, 9216
s_waitcnt vmcnt(4)
buffer_load_dwordx4 v10, s[12:15], s36 offen nt lds
s_mov_b32 exec_lo, 0xff
s_mov_b32 exec_hi, 0x0
buffer_load_dwordx4 v10, s[12:15], s36 offen offset:1024 nt lds
s_mov_b64 exec, -1
s_add_u32 m0, m0, 9472
s_add_u32 s36, s36, 9216
s_waitcnt vmcnt(4)
buffer_load_dwordx4 v10, s[12:15], s36 offen nt lds
s_mov_b32 exec_lo, 0xff
s_mov_b32 exec_hi, 0x0
buffer_load_dwordx4 v10, s[12:15], s36 offen offset:1024 nt lds
s_mov_b64 exec, -1
s_add_u32 m0, m0, 9472
s_add_u32 s36, s36, 9216
s_waitcnt vmcnt(4)
buffer_load_dwordx4 v10, s[12:15], s36 offen nt lds
s_mov_b32 exec_lo, 0xff
s_mov_b32 exec_hi, 0x0
buffer_load_dwordx4 v10, s[12:15], s36 offen offset:1024 nt lds
s_mov_b64 exec, -1
s_add_u32 m0, m0, 9472
s_add_u32 s36, s36, 9216
s_waitcnt vmcnt(4)
buffer_load_dwordx4 v10, s[12:15], s36 offen nt lds
s_mov_b32 exec_lo, 0xff
s_mov_b32 exec_hi, 0x0
buffer_load_dwordx4 v10, s[12:15], s36 offen offset:1024 nt lds
s_mov_b64 exec, -1
s_add_u32 m0, m0, 9472
s_add_u32 s36, s36, 9216
s_waitcnt vmcnt(4)
buffer_load_dwordx4 v10, s[12:15], s36 offen nt lds
s_mov_b32 exec_lo, 0xff
s_mov_b32 exec_hi, 0x0
buffer_load_dwordx4 v10, s[12:15], s36 offen offset:1024 nt lds
s_mov_b64 exec, -1
s_add_u32 m0, m0, 9472
s_add_u32 s36, s36, 9216
s_waitcnt vmcnt(4)
buffer_load_dwordx4 v10, s[12:15], s36 offen nt lds
s_mov_b32 exec_lo, 0xff
s_mov_b32 exec_hi, 0x0
buffer_load_dwordx4 v10, s[12:15], s36 offen offset:1024 nt lds
s_mov_b64 exec, -1
s_add_u32 m0, m0, 9472
s_add_u32 s36, s36, 9216
s_waitcnt vmcnt(18)
s_barrier
v_bfe_u32 v8, v1, 2, 2
v_and_b32 v9, 1, v3
v_lshl_or_b32 v9, v9, 2, v8
v_xor_b32 v9, s3, v9
v_lshlrev_b32 v9, 5, v9
v_lshl_add_u32 v8, v3, 3, v8
v_lshl_add_u32 v8, v8, 8, v9
v_and_b32 v9, 3, v1
v_lshl_add_u32 v8, v9, 3, v8
v_add_u32 v8, 98304, v8
ds_read_b64_tr_b16 v[16:17], v8 offset:0
ds_read_b64_tr_b16 v[18:19], v8 offset:1024
ds_read_b64_tr_b16 v[20:21], v8 offset:8192
ds_read_b64_tr_b16 v[22:23], v8 offset:9216
ds_read_b64_tr_b16 v[24:25], v8 offset:16384
ds_read_b64_tr_b16 v[26:27], v8 offset:17408
ds_read_b64_tr_b16 v[28:29], v8 offset:24576
ds_read_b64_tr_b16 v[30:31], v8 offset:25600
ds_read_b64_tr_b16 v[32:33], v8 offset:32768
ds_read_b64_tr_b16 v[34:35], v8 offset:33792
ds_read_b64_tr_b16 v[36:37], v8 offset:40960
ds_read_b64_tr_b16 v[38:39], v8 offset:41984
ds_read_b64_tr_b16 v[40:41], v8 offset:49152
ds_read_b64_tr_b16 v[42:43], v8 offset:50176
ds_read_b64_tr_b16 v[44:45], v8 offset:57344
ds_read_b64_tr_b16 v[46:47], v8 offset:58368
s_waitcnt lgkmcnt(0)
s_barrier
s_waitcnt vmcnt(4)
buffer_load_dwordx4 v10, s[12:15], s36 offen nt lds
s_mov_b32 exec_lo, 0xff
s_mov_b32 exec_hi, 0x0
buffer_load_dwordx4 v10, s[12:15], s36 offen offset:1024 nt lds
s_mov_b64 exec, -1
s_add_u32 m0, m0, 9472
s_add_u32 s36, s36, 9216
s_waitcnt vmcnt(4)
s_barrier
ds_read_b64_tr_b16 v[48:49], v240 offset:0
ds_read_b64_tr_b16 v[50:51], v240 offset:9472
ds_read_b64_tr_b16 v[52:53], v240 offset:37888
ds_read_b64_tr_b16 v[54:55], v240 offset:47360
ds_read_b64_tr_b16 v[64:65], v240 offset:32
ds_read_b64_tr_b16 v[66:67], v240 offset:9504
ds_read_b64_tr_b16 v[68:69], v240 offset:37920
ds_read_b64_tr_b16 v[70:71], v240 offset:47392
ds_read_b64_tr_b16 v[80:81], v240 offset:64
ds_read_b64_tr_b16 v[82:83], v240 offset:9536
ds_read_b64_tr_b16 v[84:85], v240 offset:37952
ds_read_b64_tr_b16 v[86:87], v240 offset:47424
ds_read_b64_tr_b16 v[96:97], v240 offset:96
ds_read_b64_tr_b16 v[98:99], v240 offset:9568
ds_read_b64_tr_b16 v[100:101], v240 offset:37984
ds_read_b64_tr_b16 v[102:103], v240 offset:47456
s_cmp_ge_u32 s3, 2
s_cbranch_scc1 L_nx_44
ds_read_b64_tr_b16 v[112:113], v244 offset:0
ds_read_b64_tr_b16 v[114:115], v244 offset:9472
ds_read_b64_tr_b16 v[116:117], v244 offset:37888
ds_read_b64_tr_b16 v[118:119], v244 offset:47360
ds_read_b64_tr_b16 v[196:197], v244 offset:32
ds_read_b64_tr_b16 v[198:199], v244 offset:9504
ds_read_b64_tr_b16 v[200:201], v244 offset:37920
ds_read_b64_tr_b16 v[202:203], v244 offset:47392
L_nx_44:
buffer_load_dwordx4 v10, s[12:15], s36 offen nt lds
s_mov_b32 exec_lo, 0xff
s_mov_b32 exec_hi, 0x0
buffer_load_dwordx4 v10, s[12:15], s36 offen offset:1024 nt lds
s_mov_b64 exec, -1
s_add_u32 m0, m0, 9472
s_add_u32 s36, s36, 9216
s_waitcnt vmcnt(4)
buffer_load_dwordx4 v10, s[12:15], s36 offen nt lds
s_mov_b32 exec_lo, 0xff
s_mov_b32 exec_hi, 0x0
buffer_load_dwordx4 v10, s[12:15], s36 offen offset:1024 nt lds
s_mov_b64 exec, -1
s_add_u32 m0, m0, 9472
s_add_u32 s36, s36, 9216
s_waitcnt vmcnt(4)
buffer_load_dwordx4 v10, s[12:15], s36 offen nt lds
s_mov_b32 exec_lo, 0xff
s_mov_b32 exec_hi, 0x0
buffer_load_dwordx4 v10, s[12:15], s36 offen offset:1024 nt lds
s_mov_b64 exec, -1
s_add_u32 m0, m0, 9472
s_add_u32 s36, s36, 9216
s_waitcnt vmcnt(4)
buffer_load_dwordx4 v10, s[12:15], s36 offen nt lds
s_mov_b32 exec_lo, 0xff
s_mov_b32 exec_hi, 0x0
buffer_load_dwordx4 v10, s[12:15], s36 offen offset:1024 nt lds
s_mov_b64 exec, -1
s_add_u32 m0, m0, 9472
s_add_u32 s36, s36, 9216
s_waitcnt vmcnt(4)
buffer_load_dwordx4 v10, s[12:15], s36 offen nt lds
s_mov_b32 exec_lo, 0xff
s_mov_b32 exec_hi, 0x0
buffer_load_dwordx4 v10, s[12:15], s36 offen offset:1024 nt lds
s_mov_b64 exec, -1
s_add_u32 m0, m0, 9472
s_add_u32 s36, s36, 9216
s_waitcnt vmcnt(4)
buffer_load_dwordx4 v10, s[12:15], s36 offen nt lds
s_mov_b32 exec_lo, 0xff
s_mov_b32 exec_hi, 0x0
buffer_load_dwordx4 v10, s[12:15], s36 offen offset:1024 nt lds
s_mov_b64 exec, -1
v_lshlrev_b32 v8, 12, v3
v_lshl_add_u32 v8, v2, 4, v8
s_lshl_b32 s36, s34, 1
s_add_u32 s36, s36, s35
s_lshl_b32 s36, s36, 16
s_lshr_b32 s37, s3, 1
s_lshl_b32 s37, s37, 14
s_add_u32 s36, s36, s37
s_and_b32 s37, s3, 1
s_lshl_b32 s37, s37, 8
s_add_u32 s36, s36, s37
s_add_u32 s36, s36, 1048576
v_and_b32 v12, 3, v1
v_lshlrev_b32 v12, 3, v12
v_lshrrev_b32 v12, v12, s92
v_bfe_u32 v216, v12, 1, 1
v_lshlrev_b32 v216, 16, v216
v_bfe_u32 v13, v12, 0, 1
v_or_b32 v216, v216, v13
v_bfe_u32 v217, v12, 3, 1
v_lshlrev_b32 v217, 16, v217
v_bfe_u32 v13, v12, 2, 1
v_or_b32 v217, v217, v13
v_bfe_u32 v218, v12, 5, 1
v_lshlrev_b32 v218, 16, v218
v_bfe_u32 v13, v12, 4, 1
v_or_b32 v218, v218, v13
v_bfe_u32 v219, v12, 7, 1
v_lshlrev_b32 v219, 16, v219
v_bfe_u32 v13, v12, 6, 1
v_or_b32 v219, v219, v13
v_lshlrev_b32 v9, 5, v2
v_lshl_add_u32 v9, v3, 4, v9
s_lshl_b32 s37, s3, 9
v_add_u32 v10, s37, v9
v_and_b32 v12, 7, v2
v_lshl_add_u32 v12, v3, 3, v12
s_lshl_b32 s37, s3, 7
v_lshl_add_u32 v11, v12, 2, s37
s_lshr_b32 s37, s3, 1
s_mul_i32 s37, s37, 576
s_and_b32 s38, s3, 1
s_lshl_b32 s38, s38, 8
s_add_u32 s37, s37, s38
v_lshrrev_b32 v10, 1, v9
v_add_u32 v10, s37, v10
v_and_b32 v11, 3, v2
v_mul_u32_u24 v11, 576, v11
v_lshl_add_u32 v11, v3, 4, v11
s_lshr_b32 s37, s3, 1
s_lshl_b32 s37, s37, 7
v_lshl_add_u32 v14, v12, 2, s37
s_mov_b32 s38, 0xff00ff00
s_mov_b32 s39, 0xff00ff00
v_cndmask_b32 v232, v4, 0, s[38:39]
v_cndmask_b32 v236, 0, v4, s[38:39]
v_cndmask_b32 v233, v5, 0, s[38:39]
v_cndmask_b32 v237, 0, v5, s[38:39]
v_cndmask_b32 v234, v6, 0, s[38:39]
v_cndmask_b32 v238, 0, v6, s[38:39]
v_cndmask_b32 v235, v7, 0, s[38:39]
v_cndmask_b32 v239, 0, v7, s[38:39]
v_and_b32 v12, 3, v2
v_lshl_add_u32 v12, v3, 2, v12
s_lshl_b32 s37, s3, 6
v_lshl_add_u32 v228, v12, 2, s37
v_and_b32 v12, 1, v3
v_lshlrev_b32 v229, 5, v2
v_lshl_add_u32 v229, v12, 4, v229
v_lshrrev_b32 v12, 1, v3
v_lshl_add_u32 v229, v12, 9, v229
s_mul_i32 s37, s3, 2304
v_add_u32 v229, s37, v229
v_and_b32 v228, 3, v2
v_bfe_u32 v12, v2, 2, 1
v_lshl_or_b32 v228, v12, 3, v228
v_bfe_u32 v12, v2, 3, 1
v_lshl_or_b32 v228, v12, 2, v228
s_lshl_b32 s37, s3, 4
v_add_u32 v228, s37, v228
v_lshlrev_b32 v228, 1, v228
v_lshlrev_b32 v229, 4, v3
v_bfe_u32 v12, v2, 2, 1
v_lshlrev_b32 v231, 6, v12
v_lshl_add_u32 v231, v3, 4, v231
v_bfe_u32 v12, v2, 3, 1
v_lshl_add_u32 v230, v12, 13, v231
s_lshl_b32 s37, s3, 14
v_add_u32 v230, s37, v230
s_add_u32 s37, s3, 16
s_lshl_b32 s37, s37, 13
v_add_u32 v231, s37, v231
s_lshl_b32 s41, s40, 7
s_add_u32 s41, s41, 524288
s_waitcnt vmcnt(0)
s_barrier
ds_read_b64_tr_b16 v[56:57], v241 offset:0
ds_read_b64_tr_b16 v[58:59], v241 offset:9472
ds_read_b64_tr_b16 v[60:61], v241 offset:37888
ds_read_b64_tr_b16 v[62:63], v241 offset:47360
ds_read_b64_tr_b16 v[72:73], v241 offset:32
ds_read_b64_tr_b16 v[74:75], v241 offset:9504
ds_read_b64_tr_b16 v[76:77], v241 offset:37920
ds_read_b64_tr_b16 v[78:79], v241 offset:47392
ds_read_b64_tr_b16 v[88:89], v241 offset:64
ds_read_b64_tr_b16 v[90:91], v241 offset:9536
ds_read_b64_tr_b16 v[92:93], v241 offset:37952
ds_read_b64_tr_b16 v[94:95], v241 offset:47424
ds_read_b64_tr_b16 v[104:105], v241 offset:96
ds_read_b64_tr_b16 v[106:107], v241 offset:9568
ds_read_b64_tr_b16 v[108:109], v241 offset:37984
ds_read_b64_tr_b16 v[110:111], v241 offset:47456
s_cmp_ge_u32 s3, 2
s_cbranch_scc1 L_nx_45
ds_read_b64_tr_b16 v[120:121], v245 offset:0
ds_read_b64_tr_b16 v[122:123], v245 offset:9472
ds_read_b64_tr_b16 v[124:125], v245 offset:37888
ds_read_b64_tr_b16 v[126:127], v245 offset:47360
ds_read_b64_tr_b16 v[204:205], v245 offset:32
ds_read_b64_tr_b16 v[206:207], v245 offset:9504
ds_read_b64_tr_b16 v[208:209], v245 offset:37920
ds_read_b64_tr_b16 v[210:211], v245 offset:47392
L_nx_45:
s_cmp_lg_u32 s3, 1
s_cbranch_scc1 L_ofl_46
v_lshlrev_b32 v13, 2, v1
v_add_u32 v13, 8192, v13
buffer_load_dword v12, v13, s[28:31], 0 offen sc1
s_waitcnt vmcnt(0)
s_branch L_flc_49
L_fla_47:
buffer_load_dword v12, v13, s[28:31], 0 offen sc1
s_waitcnt vmcnt(0)
L_flc_49:
v_cmp_ne_u32 vcc, s92, v12
s_nop 0
s_cbranch_vccz L_flo_48
s_cmp_eq_u32 s95, 0
s_cbranch_scc1 L_flo_48
s_sub_u32 s95, s95, 1
s_branch L_fla_47
L_flo_48:
L_ofl_46:
s_and_b32 s38, s94, 3
s_lshl_b32 s38, s38, 3
s_lshl_b32 s39, s93, 13
s_add_u32 s39, s39, s38
s_add_u32 s39, s39, 819200
s_add_u32 s33, s39, 4096
v_lshlrev_b32 v13, 6, v1
v_lshlrev_b32 v242, 2, v1
v_mov_b32 v243, 512
v_not_b32 v12, s92
ds_write_b32 v243, v12 offset:4
s_waitcnt lgkmcnt(0)
s_cmp_lg_u32 s3, 0
s_cbranch_scc1 L_ml_50
v_lshlrev_b32 v15, 7, v1
s_lshl_b32 s37, s93, 14
s_add_u32 s37, s37, s38
s_add_u32 s37, s37, 917504
s_add_u32 s38, s37, 8192
L_mla_51:
buffer_load_dwordx2 v[220:221], v15, s[28:31], s37 offen sc1
buffer_load_dwordx2 v[224:225], v15, s[28:31], s38 offen sc1
s_waitcnt vmcnt(0)
v_sad_u32 v12, v221, s92, 0
v_sad_u32 v12, v225, s92, v12
v_cmp_ne_u32 vcc, 0, v12
s_nop 0
s_cbranch_vccz L_mlo_52
s_cmp_eq_u32 s95, 0
s_cbranch_scc1 L_mlo_52
s_sub_u32 s95, s95, 1
s_branch L_mla_51
L_mlo_52:
s_barrier
v_max_f32 v12, v220, v224
s_nop 1
v_max_f32_dpp v12, v12, v12 row_ror:8 row_mask:0xf bank_mask:0xf
s_nop 1
v_max_f32_dpp v12, v12, v12 row_ror:4 row_mask:0xf bank_mask:0xf
s_nop 1
v_max_f32_dpp v12, v12, v12 row_ror:2 row_mask:0xf bank_mask:0xf
s_nop 1
v_max_f32_dpp v12, v12, v12 row_ror:1 row_mask:0xf bank_mask:0xf
s_nop 1
v_max_f32_dpp v12, v12, v12 row_bcast:15 row_mask:0xa bank_mask:0xf
s_nop 1
v_max_f32_dpp v12, v12, v12 row_bcast:31 row_mask:0xc bank_mask:0xf
s_nop 0
v_readlane_b32 s38, v12, 63
s_nop 1
v_subrev_f32 v220, s38, v220
v_subrev_f32 v224, s38, v224
v_exp_f32 v220, v220
v_exp_f32 v224, v224
v_cvt_pk_bf16_f32 v12, v220, v220
v_cvt_pk_bf16_f32 v13, v224, v224
ds_write_b32 v242, v12 offset:0
ds_write_b32 v242, v13 offset:256
ds_write_b32 v243, v221 offset:4
buffer_load_dwordx4 v[128:131], v8, s[28:31], s36 offen offset:0 sc1
buffer_load_dwordx4 v[132:135], v8, s[28:31], s36 offen offset:512 sc1
buffer_load_dwordx4 v[136:139], v8, s[28:31], s36 offen offset:1024 sc1
buffer_load_dwordx4 v[140:143], v8, s[28:31], s36 offen offset:1536 sc1
buffer_load_dwordx4 v[144:147], v8, s[28:31], s36 offen offset:2048 sc1
buffer_load_dwordx4 v[148:151], v8, s[28:31], s36 offen offset:2560 sc1
buffer_load_dwordx4 v[152:155], v8, s[28:31], s36 offen offset:3072 sc1
buffer_load_dwordx4 v[156:159], v8, s[28:31], s36 offen offset:3584 sc1
s_branch L_mj_53
L_ml_50:
s_barrier
s_cmp_lg_u32 s3, 1
s_cbranch_scc1 L_nol_54
buffer_load_dwordx2 v[222:223], v13, s[28:31], s39 offen sc1
buffer_load_dwordx2 v[226:227], v13, s[28:31], s33 offen sc1
L_nol_54:
buffer_load_dwordx4 v[128:131], v8, s[28:31], s36 offen offset:0 sc1
buffer_load_dwordx4 v[132:135], v8, s[28:31], s36 offen offset:512 sc1
buffer_load_dwordx4 v[136:139], v8, s[28:31], s36 offen offset:1024 sc1
buffer_load_dwordx4 v[140:143], v8, s[28:31], s36 offen offset:1536 sc1
buffer_load_dwordx4 v[144:147], v8, s[28:31], s36 offen offset:2048 sc1
buffer_load_dwordx4 v[148:151], v8, s[28:31], s36 offen offset:2560 sc1
buffer_load_dwordx4 v[152:155], v8, s[28:31], s36 offen offset:3072 sc1
buffer_load_dwordx4 v[156:159], v8, s[28:31], s36 offen offset:3584 sc1
L_mj_53:
L_fwa_59:
ds_read_b32 v12, v243 offset:4
ds_read_b32 v15, v14 offset:0
ds_read2st64_b32 v[220:221], v242 offset0:0 offset1:1
s_waitcnt lgkmcnt(0)
v_cmp_ne_u32 vcc, s92, v12
s_nop 0
s_cbranch_vccz L_fwo_60
s_cmp_eq_u32 s95, 0
s_cbranch_scc1 L_fwo_60
s_sub_u32 s95, s95, 1
s_branch L_fwa_59
L_fwo_60:
v_and_b32_dpp v160, v15, v4 row_newbcast:0 row_mask:0xf bank_mask:0xf
v_and_b32_dpp v161, v15, v5 row_newbcast:0 row_mask:0xf bank_mask:0xf
v_and_b32_dpp v162, v15, v6 row_newbcast:0 row_mask:0xf bank_mask:0xf
v_and_b32_dpp v163, v15, v7 row_newbcast:0 row_mask:0xf bank_mask:0xf
v_and_b32_dpp v164, v15, v4 row_newbcast:1 row_mask:0xf bank_mask:0xf
v_and_b32_dpp v165, v15, v5 row_newbcast:1 row_mask:0xf bank_mask:0xf
v_and_b32_dpp v166, v15, v6 row_newbcast:1 row_mask:0xf bank_mask:0xf
v_and_b32_dpp v167, v15, v7 row_newbcast:1 row_mask:0xf bank_mask:0xf
v_and_b32_dpp v168, v15, v4 row_newbcast:2 row_mask:0xf bank_mask:0xf
v_and_b32_dpp v169, v15, v5 row_newbcast:2 row_mask:0xf bank_mask:0xf
v_and_b32_dpp v170, v15, v6 row_newbcast:2 row_mask:0xf bank_mask:0xf
v_and_b32_dpp v171, v15, v7 row_newbcast:2 row_mask:0xf bank_mask:0xf
v_and_b32_dpp v172, v15, v4 row_newbcast:3 row_mask:0xf bank_mask:0xf
v_and_b32_dpp v173, v15, v5 row_newbcast:3 row_mask:0xf bank_mask:0xf
v_and_b32_dpp v174, v15, v6 row_newbcast:3 row_mask:0xf bank_mask:0xf
v_and_b32_dpp v175, v15, v7 row_newbcast:3 row_mask:0xf bank_mask:0xf
v_and_b32_dpp v176, v15, v4 row_newbcast:4 row_mask:0xf bank_mask:0xf
v_and_b32_dpp v177, v15, v5 row_newbcast:4 row_mask:0xf bank_mask:0xf
v_and_b32_dpp v178, v15, v6 row_newbcast:4 row_mask:0xf bank_mask:0xf
v_and_b32_dpp v179, v15, v7 row_newbcast:4 row_mask:0xf bank_mask:0xf
v_and_b32_dpp v180, v15, v4 row_newbcast:5 row_mask:0xf bank_mask:0xf
v_and_b32_dpp v181, v15, v5 row_newbcast:5 row_mask:0xf bank_mask:0xf
v_and_b32_dpp v182, v15, v6 row_newbcast:5 row_mask:0xf bank_mask:0xf
v_and_b32_dpp v183, v15, v7 row_newbcast:5 row_mask:0xf bank_mask:0xf
v_and_b32_dpp v184, v15, v4 row_newbcast:6 row_mask:0xf bank_mask:0xf
v_and_b32_dpp v185, v15, v5 row_newbcast:6 row_mask:0xf bank_mask:0xf
v_and_b32_dpp v186, v15, v6 row_newbcast:6 row_mask:0xf bank_mask:0xf
v_and_b32_dpp v187, v15, v7 row_newbcast:6 row_mask:0xf bank_mask:0xf
v_and_b32_dpp v188, v15, v4 row_newbcast:7 row_mask:0xf bank_mask:0xf
v_and_b32_dpp v189, v15, v5 row_newbcast:7 row_mask:0xf bank_mask:0xf
v_and_b32_dpp v190, v15, v6 row_newbcast:7 row_mask:0xf bank_mask:0xf
v_and_b32_dpp v191, v15, v7 row_newbcast:7 row_mask:0xf bank_mask:0xf
s_cmp_lg_u32 s3, 1
s_cbranch_scc1 L_nol_61
v_and_b32 v220, 0xffff0000, v220
v_and_b32 v221, 0xffff0000, v221
s_waitcnt vmcnt(8)
s_branch L_llc_64
L_lla_62:
buffer_load_dwordx2 v[222:223], v13, s[28:31], s39 offen sc1
buffer_load_dwordx2 v[226:227], v13, s[28:31], s33 offen sc1
s_waitcnt vmcnt(0)
L_llc_64:
v_sad_u32 v12, v223, s92, 0
v_sad_u32 v12, v227, s92, v12
v_cmp_ne_u32 vcc, 0, v12
s_nop 0
s_cbranch_vccz L_llo_63
s_cmp_eq_u32 s95, 0
s_cbranch_scc1 L_llo_63
s_sub_u32 s95, s95, 1
s_branch L_lla_62
L_llo_63:
v_mul_f32 v12, v220, v222
v_fmac_f32 v12, v221, v226
s_nop 1
v_add_f32_dpp v12, v12, v12 row_ror:8 row_mask:0xf bank_mask:0xf
s_nop 1
v_add_f32_dpp v12, v12, v12 row_ror:4 row_mask:0xf bank_mask:0xf
s_nop 1
v_add_f32_dpp v12, v12, v12 row_ror:2 row_mask:0xf bank_mask:0xf
s_nop 1
v_add_f32_dpp v12, v12, v12 row_ror:1 row_mask:0xf bank_mask:0xf
s_nop 1
v_add_f32_dpp v12, v12, v12 row_bcast:15 row_mask:0xa bank_mask:0xf
s_nop 1
v_add_f32_dpp v12, v12, v12 row_bcast:31 row_mask:0xc bank_mask:0xf
v_rcp_f32 v12, v12
s_mov_b32 exec_lo, 0x0
s_mov_b32 exec_hi, 0x80000000
ds_write_b32 v243, v12
s_mov_b64 exec, -1
L_nol_61:
s_waitcnt vmcnt(7)
v_xor_b32 v128, v216, v128
v_xor_b32 v129, v217, v129
v_xor_b32 v130, v218, v130
v_xor_b32 v131, v219, v131
v_or_b32 v12, v128, v129
v_or3_b32 v12, v12, v130, v131
v_mfma_f32_16x16x32_bf16 v[192:195], v[160:163], v[128:131], 0
s_waitcnt vmcnt(6)
v_xor_b32 v132, v216, v132
v_xor_b32 v133, v217, v133
v_xor_b32 v134, v218, v134
v_xor_b32 v135, v219, v135
v_or3_b32 v12, v12, v132, v133
v_or3_b32 v12, v12, v134, v135
v_mfma_f32_16x16x32_bf16 v[192:195], v[164:167], v[132:135], v[192:195]
s_waitcnt vmcnt(5)
v_xor_b32 v136, v216, v136
v_xor_b32 v137, v217, v137
v_xor_b32 v138, v218, v138
v_xor_b32 v139, v219, v139
v_or3_b32 v12, v12, v136, v137
v_or3_b32 v12, v12, v138, v139
v_mfma_f32_16x16x32_bf16 v[192:195], v[168:171], v[136:139], v[192:195]
s_waitcnt vmcnt(4)
v_xor_b32 v140, v216, v140
v_xor_b32 v141, v217, v141
v_xor_b32 v142, v218, v142
v_xor_b32 v143, v219, v143
v_or3_b32 v12, v12, v140, v141
v_or3_b32 v12, v12, v142, v143
v_mfma_f32_16x16x32_bf16 v[192:195], v[172:175], v[140:143], v[192:195]
s_waitcnt vmcnt(3)
v_xor_b32 v144, v216, v144
v_xor_b32 v145, v217, v145
v_xor_b32 v146, v218, v146
v_xor_b32 v147, v219, v147
v_or3_b32 v12, v12, v144, v145
v_or3_b32 v12, v12, v146, v147
v_mfma_f32_16x16x32_bf16 v[192:195], v[176:179], v[144:147], v[192:195]
s_waitcnt vmcnt(2)
v_xor_b32 v148, v216, v148
v_xor_b32 v149, v217, v149
v_xor_b32 v150, v218, v150
v_xor_b32 v151, v219, v151
v_or3_b32 v12, v12, v148, v149
v_or3_b32 v12, v12, v150, v151
v_mfma_f32_16x16x32_bf16 v[192:195], v[180:183], v[148:151], v[192:195]
s_waitcnt vmcnt(1)
v_xor_b32 v152, v216, v152
v_xor_b32 v153, v217, v153
v_xor_b32 v154, v218, v154
v_xor_b32 v155, v219, v155
v_or3_b32 v12, v12, v152, v153
v_or3_b32 v12, v12, v154, v155
v_mfma_f32_16x16x32_bf16 v[192:195], v[184:187], v[152:155], v[192:195]
s_waitcnt vmcnt(0)
v_xor_b32 v156, v216, v156
v_xor_b32 v157, v217, v157
v_xor_b32 v158, v218, v158
v_xor_b32 v159, v219, v159
v_or3_b32 v12, v12, v156, v157
v_or3_b32 v12, v12, v158, v159
v_and_b32 v12, 0x10001, v12
v_cmp_ne_u32 vcc, 0, v12
v_mfma_f32_16x16x32_bf16 v[192:195], v[188:191], v[156:159], v[192:195]
s_cbranch_vccz L_ppo_56
L_ppa_55:
s_mov_b32 s38, 0
v_or3_b32 v12, v128, v129, v130
v_or_b32 v12, v12, v131
v_and_b32 v12, 0x10001, v12
v_cmp_ne_u32 vcc, 0, v12
s_nop 0
s_cbranch_vccz L_pn_65
buffer_load_dwordx4 v[128:131], v8, s[28:31], s36 offen offset:0 sc1
s_bitset1_b32 s38, 0
L_pn_65:
v_or3_b32 v12, v132, v133, v134
v_or_b32 v12, v12, v135
v_and_b32 v12, 0x10001, v12
v_cmp_ne_u32 vcc, 0, v12
s_nop 0
s_cbranch_vccz L_pn_66
buffer_load_dwordx4 v[132:135], v8, s[28:31], s36 offen offset:512 sc1
s_bitset1_b32 s38, 1
L_pn_66:
v_or3_b32 v12, v136, v137, v138
v_or_b32 v12, v12, v139
v_and_b32 v12, 0x10001, v12
v_cmp_ne_u32 vcc, 0, v12
s_nop 0
s_cbranch_vccz L_pn_67
buffer_load_dwordx4 v[136:139], v8, s[28:31], s36 offen offset:1024 sc1
s_bitset1_b32 s38, 2
L_pn_67:
v_or3_b32 v12, v140, v141, v142
v_or_b32 v12, v12, v143
v_and_b32 v12, 0x10001, v12
v_cmp_ne_u32 vcc, 0, v12
s_nop 0
s_cbranch_vccz L_pn_68
buffer_load_dwordx4 v[140:143], v8, s[28:31], s36 offen offset:1536 sc1
s_bitset1_b32 s38, 3
L_pn_68:
v_or3_b32 v12, v144, v145, v146
v_or_b32 v12, v12, v147
v_and_b32 v12, 0x10001, v12
v_cmp_ne_u32 vcc, 0, v12
s_nop 0
s_cbranch_vccz L_pn_69
buffer_load_dwordx4 v[144:147], v8, s[28:31], s36 offen offset:2048 sc1
s_bitset1_b32 s38, 4
L_pn_69:
v_or3_b32 v12, v148, v149, v150
v_or_b32 v12, v12, v151
v_and_b32 v12, 0x10001, v12
v_cmp_ne_u32 vcc, 0, v12
s_nop 0
s_cbranch_vccz L_pn_70
buffer_load_dwordx4 v[148:151], v8, s[28:31], s36 offen offset:2560 sc1
s_bitset1_b32 s38, 5
L_pn_70:
v_or3_b32 v12, v152, v153, v154
v_or_b32 v12, v12, v155
v_and_b32 v12, 0x10001, v12
v_cmp_ne_u32 vcc, 0, v12
s_nop 0
s_cbranch_vccz L_pn_71
buffer_load_dwordx4 v[152:155], v8, s[28:31], s36 offen offset:3072 sc1
s_bitset1_b32 s38, 6
L_pn_71:
v_or3_b32 v12, v156, v157, v158
v_or_b32 v12, v12, v159
v_and_b32 v12, 0x10001, v12
v_cmp_ne_u32 vcc, 0, v12
s_nop 0
s_cbranch_vccz L_pn_72
buffer_load_dwordx4 v[156:159], v8, s[28:31], s36 offen offset:3584 sc1
s_bitset1_b32 s38, 7
L_pn_72:
s_cmp_eq_u32 s38, 0
s_cbranch_scc1 L_ppr_57
L_ppl_58:
s_waitcnt vmcnt(0)
s_bitcmp1_b32 s38, 0
s_cbranch_scc0 L_px_73
v_xor_b32 v128, v216, v128
v_xor_b32 v129, v217, v129
v_xor_b32 v130, v218, v130
v_xor_b32 v131, v219, v131
L_px_73:
s_bitcmp1_b32 s38, 1
s_cbranch_scc0 L_px_74
v_xor_b32 v132, v216, v132
v_xor_b32 v133, v217, v133
v_xor_b32 v134, v218, v134
v_xor_b32 v135, v219, v135
L_px_74:
s_bitcmp1_b32 s38, 2
s_cbranch_scc0 L_px_75
v_xor_b32 v136, v216, v136
v_xor_b32 v137, v217, v137
v_xor_b32 v138, v218, v138
v_xor_b32 v139, v219, v139
L_px_75:
s_bitcmp1_b32 s38, 3
s_cbranch_scc0 L_px_76
v_xor_b32 v140, v216, v140
v_xor_b32 v141, v217, v141
v_xor_b32 v142, v218, v142
v_xor_b32 v143, v219, v143
L_px_76:
s_bitcmp1_b32 s38, 4
s_cbranch_scc0 L_px_77
v_xor_b32 v144, v216, v144
v_xor_b32 v145, v217, v145
v_xor_b32 v146, v218, v146
v_xor_b32 v147, v219, v147
L_px_77:
s_bitcmp1_b32 s38, 5
s_cbranch_scc0 L_px_78
v_xor_b32 v148, v216, v148
v_xor_b32 v149, v217, v149
v_xor_b32 v150, v218, v150
v_xor_b32 v151, v219, v151
L_px_78:
s_bitcmp1_b32 s38, 6
s_cbranch_scc0 L_px_79
v_xor_b32 v152, v216, v152
v_xor_b32 v153, v217, v153
v_xor_b32 v154, v218, v154
v_xor_b32 v155, v219, v155
L_px_79:
s_bitcmp1_b32 s38, 7
s_cbranch_scc0 L_px_80
v_xor_b32 v156, v216, v156
v_xor_b32 v157, v217, v157
v_xor_b32 v158, v218, v158
v_xor_b32 v159, v219, v159
L_px_80:
s_cmp_eq_u32 s95, 0
s_cbranch_scc1 L_ppr_57
s_sub_u32 s95, s95, 1
s_branch L_ppa_55
L_ppr_57:
s_nop 1
v_mfma_f32_16x16x32_bf16 v[192:195], v[160:163], v[128:131], 0
v_mfma_f32_16x16x32_bf16 v[192:195], v[164:167], v[132:135], v[192:195]
v_mfma_f32_16x16x32_bf16 v[192:195], v[168:171], v[136:139], v[192:195]
v_mfma_f32_16x16x32_bf16 v[192:195], v[172:175], v[140:143], v[192:195]
v_mfma_f32_16x16x32_bf16 v[192:195], v[176:179], v[144:147], v[192:195]
v_mfma_f32_16x16x32_bf16 v[192:195], v[180:183], v[148:151], v[192:195]
v_mfma_f32_16x16x32_bf16 v[192:195], v[184:187], v[152:155], v[192:195]
v_mfma_f32_16x16x32_bf16 v[192:195], v[188:191], v[156:159], v[192:195]
L_ppo_56:
s_nop 4
s_nop 2
v_cvt_pk_bf16_f32 v128, v192, v193
v_cvt_pk_bf16_f32 v129, v194, v195
s_mov_b32 exec_lo, 0xffffffff
s_mov_b32 exec_hi, 0x0
ds_write_b64 v10, v[128:129] offset:1024
s_mov_b64 exec, -1
s_waitcnt lgkmcnt(0)
s_barrier
ds_read_b128 v[160:163], v11 offset:1024
ds_read_b128 v[164:167], v11 offset:1088
ds_read_b128 v[168:171], v11 offset:1152
ds_read_b128 v[172:175], v11 offset:1216
ds_read_b128 v[176:179], v11 offset:1280
ds_read_b128 v[180:183], v11 offset:1344
ds_read_b128 v[184:187], v11 offset:1408
ds_read_b128 v[188:191], v11 offset:1472
ds_read_b32 v12, v243
s_waitcnt lgkmcnt(8)
v_mfma_f32_16x16x32_bf16 v[192:195], v[160:163], v[16:19], 0
s_waitcnt lgkmcnt(7)
v_mfma_f32_16x16x32_bf16 v[192:195], v[164:167], v[20:23], v[192:195]
s_waitcnt lgkmcnt(6)
v_mfma_f32_16x16x32_bf16 v[192:195], v[168:171], v[24:27], v[192:195]
s_waitcnt lgkmcnt(5)
v_mfma_f32_16x16x32_bf16 v[192:195], v[172:175], v[28:31], v[192:195]
s_waitcnt lgkmcnt(4)
v_mfma_f32_16x16x32_bf16 v[192:195], v[176:179], v[32:35], v[192:195]
s_waitcnt lgkmcnt(3)
v_mfma_f32_16x16x32_bf16 v[192:195], v[180:183], v[36:39], v[192:195]
s_waitcnt lgkmcnt(2)
v_mfma_f32_16x16x32_bf16 v[192:195], v[184:187], v[40:43], v[192:195]
s_waitcnt lgkmcnt(1)
v_mfma_f32_16x16x32_bf16 v[192:195], v[188:191], v[44:47], v[192:195]
s_waitcnt lgkmcnt(0)
s_nop 6
v_pk_add_f32 v[128:129], v[192:193], v[194:195]
v_add_f32 v128, v128, v129
v_mul_f32 v128, v128, v12
v_cvt_pk_bf16_f32 v128, v128, v128
s_mov_b32 exec_lo, 0xffff
s_mov_b32 exec_hi, 0x0
ds_write_b16 v228, v128 offset:3584
s_mov_b64 exec, -1
s_waitcnt lgkmcnt(0)
s_barrier
ds_read_b128 v[160:163], v229 offset:3584
ds_read_b128 v[164:167], v229 offset:3648
ds_read_b128 v[168:171], v229 offset:3712
ds_read_b128 v[172:175], v229 offset:3776
s_cmp_ge_u32 s3, 2
s_cbranch_scc1 L_nx_81
s_waitcnt lgkmcnt(3)
v_mfma_f32_16x16x32_bf16 v[148:151], v[112:115], v[160:163], 0
s_waitcnt lgkmcnt(2)
v_mfma_f32_16x16x32_bf16 v[148:151], v[116:119], v[164:167], v[148:151]
s_waitcnt lgkmcnt(1)
v_mfma_f32_16x16x32_bf16 v[148:151], v[120:123], v[168:171], v[148:151]
s_waitcnt lgkmcnt(0)
v_mfma_f32_16x16x32_bf16 v[148:151], v[124:127], v[172:175], v[148:151]
v_mfma_f32_16x16x32_bf16 v[152:155], v[196:199], v[160:163], 0
v_mfma_f32_16x16x32_bf16 v[152:155], v[200:203], v[164:167], v[152:155]
v_mfma_f32_16x16x32_bf16 v[152:155], v[204:207], v[168:171], v[152:155]
v_mfma_f32_16x16x32_bf16 v[152:155], v[208:211], v[172:175], v[152:155]
L_nx_81:
s_waitcnt lgkmcnt(3)
v_mfma_f32_16x16x32_bf16 v[132:135], v[48:51], v[160:163], 0
s_waitcnt lgkmcnt(2)
v_mfma_f32_16x16x32_bf16 v[132:135], v[52:55], v[164:167], v[132:135]
s_waitcnt lgkmcnt(1)
v_mfma_f32_16x16x32_bf16 v[132:135], v[56:59], v[168:171], v[132:135]
s_waitcnt lgkmcnt(0)
v_mfma_f32_16x16x32_bf16 v[132:135], v[60:63], v[172:175], v[132:135]
v_mfma_f32_16x16x32_bf16 v[136:139], v[64:67], v[160:163], 0
v_mfma_f32_16x16x32_bf16 v[136:139], v[68:71], v[164:167], v[136:139]
v_mfma_f32_16x16x32_bf16 v[136:139], v[72:75], v[168:171], v[136:139]
v_mfma_f32_16x16x32_bf16 v[136:139], v[76:79], v[172:175], v[136:139]
s_cmp_ge_u32 s3, 2
s_cbranch_scc1 L_nx_82
v_mov_b32_dpp v148, v152 quad_perm:[0,1,2,3] row_mask:0xf bank_mask:0x2
v_mov_b32_dpp v149, v153 quad_perm:[0,1,2,3] row_mask:0xf bank_mask:0x2
v_mov_b32_dpp v150, v154 quad_perm:[0,1,2,3] row_mask:0xf bank_mask:0x2
v_mov_b32_dpp v151, v155 quad_perm:[0,1,2,3] row_mask:0xf bank_mask:0x2
s_mov_b32 exec_lo, 0x110011
s_mov_b32 exec_hi, 0x110011
buffer_store_dwordx4 v[148:151], v231, s[28:31], s41 offen sc1
s_mov_b64 exec, -1
L_nx_82:
v_mfma_f32_16x16x32_bf16 v[140:143], v[80:83], v[160:163], 0
v_mfma_f32_16x16x32_bf16 v[140:143], v[84:87], v[164:167], v[140:143]
v_mfma_f32_16x16x32_bf16 v[140:143], v[88:91], v[168:171], v[140:143]
v_mfma_f32_16x16x32_bf16 v[140:143], v[92:95], v[172:175], v[140:143]
s_nop 1
v_mov_b32_dpp v132, v136 quad_perm:[0,1,2,3] row_mask:0xf bank_mask:0x2
v_mov_b32_dpp v133, v137 quad_perm:[0,1,2,3] row_mask:0xf bank_mask:0x2
v_mov_b32_dpp v134, v138 quad_perm:[0,1,2,3] row_mask:0xf bank_mask:0x2
v_mov_b32_dpp v135, v139 quad_perm:[0,1,2,3] row_mask:0xf bank_mask:0x2
v_mfma_f32_16x16x32_bf16 v[144:147], v[96:99], v[160:163], 0
v_mfma_f32_16x16x32_bf16 v[144:147], v[100:103], v[164:167], v[144:147]
v_mfma_f32_16x16x32_bf16 v[144:147], v[104:107], v[168:171], v[144:147]
v_mfma_f32_16x16x32_bf16 v[144:147], v[108:111], v[172:175], v[144:147]
v_mov_b32_dpp v132, v140 quad_perm:[0,1,2,3] row_mask:0xf bank_mask:0x4
v_mov_b32_dpp v133, v141 quad_perm:[0,1,2,3] row_mask:0xf bank_mask:0x4
v_mov_b32_dpp v134, v142 quad_perm:[0,1,2,3] row_mask:0xf bank_mask:0x4
v_mov_b32_dpp v135, v143 quad_perm:[0,1,2,3] row_mask:0xf bank_mask:0x4
s_nop 3
v_mov_b32_dpp v132, v144 quad_perm:[0,1,2,3] row_mask:0xf bank_mask:0x8
v_mov_b32_dpp v133, v145 quad_perm:[0,1,2,3] row_mask:0xf bank_mask:0x8
v_mov_b32_dpp v134, v146 quad_perm:[0,1,2,3] row_mask:0xf bank_mask:0x8
v_mov_b32_dpp v135, v147 quad_perm:[0,1,2,3] row_mask:0xf bank_mask:0x8
s_mov_b32 exec_lo, 0x11111111
s_mov_b32 exec_hi, 0x11111111
buffer_store_dwordx4 v[132:135], v230, s[28:31], s41 offen sc1
s_endpgm
L_F:
s_cmp_lg_u32 s3, 0
s_cbranch_scc1 L_nox_83
s_mov_b32 s16, s64
s_mov_b32 s17, s65
s_mov_b32 s18, 1152
s_mov_b32 s19, 0x20000
v_lshlrev_b32 v108, 4, v1
buffer_load_dwordx4 v[100:103], v108, s[16:19], 0 offen
buffer_load_dwordx4 v[104:107], v108, s[16:19], 0 offen offset:1024
L_nox_83:
s_mov_b32 s8, s70
s_mov_b32 s9, s71
s_mov_b32 s10, 4194304
s_mov_b32 s11, 0x20000
v_lshrrev_b32 v8, 1, v3
v_xor_b32 v8, v8, v2
v_lshlrev_b32 v8, 4, v8
v_lshl_add_u32 v8, v3, 13, v8
s_and_b32 s34, s3, 3
s_lshl_b32 s35, s93, 2
s_add_u32 s34, s34, s35
s_and_b32 s35, s94, 7
s_lshl_b32 s35, s35, 1
s_lshr_b32 s36, s3, 2
s_add_u32 s35, s35, s36
s_lshl_b32 s35, s35, 5
s_lshl_b32 s36, s35, 13
s_lshl_b32 s37, s34, 8
s_add_u32 s36, s36, s37
s_lshl_b32 s38, s3, 13
s_add_u32 s38, s38, 49152
s_mov_b32 m0, s38
s_waitcnt lgkmcnt(0)
buffer_load_dwordx4 v8, s[8:11], s36 offen nt lds
s_add_u32 m0, m0, 1024
s_add_u32 s36, s36, 32768
v_xor_b32 v9, 32, v8
buffer_load_dwordx4 v9, s[8:11], s36 offen nt lds
s_add_u32 m0, m0, 1024
s_add_u32 s36, s36, 32768
v_xor_b32 v9, 64, v8
buffer_load_dwordx4 v9, s[8:11], s36 offen nt lds
s_add_u32 m0, m0, 1024
s_add_u32 s36, s36, 32768
v_xor_b32 v9, 96, v8
buffer_load_dwordx4 v9, s[8:11], s36 offen nt lds
s_add_u32 m0, m0, 1024
s_add_u32 s36, s36, 32768
v_xor_b32 v9, 128, v8
buffer_load_dwordx4 v9, s[8:11], s36 offen nt lds
s_add_u32 m0, m0, 1024
s_add_u32 s36, s36, 32768
v_xor_b32 v9, 160, v8
buffer_load_dwordx4 v9, s[8:11], s36 offen nt lds
s_add_u32 m0, m0, 1024
s_add_u32 s36, s36, 32768
v_xor_b32 v9, 192, v8
buffer_load_dwordx4 v9, s[8:11], s36 offen nt lds
s_add_u32 m0, m0, 1024
s_add_u32 s36, s36, 32768
v_xor_b32 v9, 224, v8
buffer_load_dwordx4 v9, s[8:11], s36 offen nt lds
v_and_b32 v250, 1, v0
v_lshlrev_b32 v250, 4, v250
v_mov_b32 v251, 0xffff
v_lshlrev_b32 v250, v250, v251
s_mov_b32 s32, 0x3030303
s_mov_b32 s33, 0x3030303
v_cndmask_b32 v4, 0, v250, s[32:33]
s_mov_b32 s32, 0xc0c0c0c
s_mov_b32 s33, 0xc0c0c0c
v_cndmask_b32 v5, 0, v250, s[32:33]
s_mov_b32 s32, 0x30303030
s_mov_b32 s33, 0x30303030
v_cndmask_b32 v6, 0, v250, s[32:33]
s_mov_b32 s32, 0xc0c0c0c0
s_mov_b32 s33, 0xc0c0c0c0
v_cndmask_b32 v7, 0, v250, s[32:33]
s_waitcnt lgkmcnt(0)
s_add_u32 s92, s92, 0x9e3779b9
v_xor_b32 v12, v3, v2
v_lshlrev_b32 v12, 4, v12
v_lshl_add_u32 v12, v2, 9, v12
v_add_u32 v12, s38, v12
v_xor_b32 v13, 64, v12
v_xor_b32 v14, 128, v12
v_xor_b32 v15, 192, v12
v_lshlrev_b32 v9, 4, v1
s_lshl_b32 s36, s34, 11
s_add_u32 s36, s36, 65536
s_lshl_b32 s37, s93, 7
s_add_u32 s37, s37, 4096
v_mov_b32 v10, 0
v_lshrrev_b32 v197, 5, v1
v_mul_u32_u24 v197, 272, v197
v_and_b32 v198, 31, v1
v_lshl_add_u32 v198, v198, 3, v197
v_and_b32 v199, 3, v1
v_mul_u32_u24 v199, 272, v199
v_lshl_add_u32 v199, v3, 4, v199
s_and_b32 s38, s3, 3
s_mul_i32 s38, s38, 1088
v_add_u32 v198, s38, v198
v_add_u32 v199, s38, v199
s_lshl_b32 s38, s34, 10
s_lshl_b32 s39, s35, 1
s_add_u32 s38, s38, s39
s_add_u32 s38, s38, 393216
v_lshlrev_b32 v11, 2, v2
s_mov_b32 s39, 0x3e0293ee
s_cmp_lg_u32 s3, 0
s_cbranch_scc1 L_nox_84
s_waitcnt vmcnt(8)
s_mov_b32 s40, s37
v_lshlrev_b32 v112, 16, v100
v_and_b32 v113, 0xffff0000, v100
v_lshlrev_b32 v114, 16, v101
v_and_b32 v115, 0xffff0000, v101
v_lshlrev_b32 v116, 16, v102
v_and_b32 v117, 0xffff0000, v102
v_lshlrev_b32 v118, 16, v103
v_and_b32 v119, 0xffff0000, v103
v_lshlrev_b32 v120, 16, v104
v_and_b32 v121, 0xffff0000, v104
v_lshlrev_b32 v122, 16, v105
v_and_b32 v123, 0xffff0000, v105
v_lshlrev_b32 v124, 16, v106
v_and_b32 v125, 0xffff0000, v106
v_lshlrev_b32 v126, 16, v107
v_and_b32 v127, 0xffff0000, v107
v_pk_add_f32 v[128:129], v[112:113], v[120:121]
v_pk_add_f32 v[130:131], v[114:115], v[122:123]
v_pk_add_f32 v[132:133], v[116:117], v[124:125]
v_pk_add_f32 v[134:135], v[118:119], v[126:127]
v_pk_add_f32 v[128:129], v[128:129], v[132:133]
v_pk_add_f32 v[130:131], v[130:131], v[134:135]
v_pk_add_f32 v[128:129], v[128:129], v[130:131]
v_add_f32 v128, v128, v129
s_nop 1
v_add_f32_dpp v128, v128, v128 row_ror:8 row_mask:0xf bank_mask:0xf
s_nop 1
v_add_f32_dpp v128, v128, v128 row_ror:4 row_mask:0xf bank_mask:0xf
s_nop 1
v_add_f32_dpp v128, v128, v128 row_ror:2 row_mask:0xf bank_mask:0xf
s_nop 1
v_add_f32_dpp v128, v128, v128 row_ror:1 row_mask:0xf bank_mask:0xf
s_nop 1
v_add_f32_dpp v128, v128, v128 row_bcast:15 row_mask:0xa bank_mask:0xf
s_nop 1
v_add_f32_dpp v128, v128, v128 row_bcast:31 row_mask:0xc bank_mask:0xf
s_nop 0
v_readlane_b32 s37, v128, 63
v_mov_b32 v128, 0x3ae38e39
s_nop 0
v_mul_f32 v128, s37, v128
v_cvt_pk_bf16_f32 v129, v128, v128
v_and_b32 v129, 0xffff0000, v129
v_sub_f32 v130, v112, v128
v_sub_f32 v131, v113, v128
v_sub_f32 v132, v114, v128
v_sub_f32 v133, v115, v128
v_sub_f32 v134, v116, v128
v_sub_f32 v135, v117, v128
v_sub_f32 v136, v118, v128
v_sub_f32 v137, v119, v128
v_mul_f32 v138, v130, v130
v_mul_f32 v139, v131, v131
v_fmac_f32 v138, v132, v132
v_fmac_f32 v139, v133, v133
v_fmac_f32 v138, v134, v134
v_fmac_f32 v139, v135, v135
v_fmac_f32 v138, v136, v136
v_fmac_f32 v139, v137, v137
s_mov_b32 exec_lo, 0xff
s_mov_b32 exec_hi, 0x0
v_sub_f32 v130, v120, v128
v_sub_f32 v131, v121, v128
v_sub_f32 v132, v122, v128
v_sub_f32 v133, v123, v128
v_sub_f32 v134, v124, v128
v_sub_f32 v135, v125, v128
v_sub_f32 v136, v126, v128
v_sub_f32 v137, v127, v128
v_fmac_f32 v138, v130, v130
v_fmac_f32 v139, v131, v131
v_fmac_f32 v138, v132, v132
v_fmac_f32 v139, v133, v133
v_fmac_f32 v138, v134, v134
v_fmac_f32 v139, v135, v135
v_fmac_f32 v138, v136, v136
v_fmac_f32 v139, v137, v137
s_mov_b64 exec, -1
v_add_f32 v138, v138, v139
v_sub_f32 v112, v112, v129
v_sub_f32 v113, v113, v129
v_add_f32_dpp v138, v138, v138 row_ror:8 row_mask:0xf bank_mask:0xf
v_sub_f32 v114, v114, v129
v_sub_f32 v115, v115, v129
v_add_f32_dpp v138, v138, v138 row_ror:4 row_mask:0xf bank_mask:0xf
v_sub_f32 v116, v116, v129
v_sub_f32 v117, v117, v129
v_add_f32_dpp v138, v138, v138 row_ror:2 row_mask:0xf bank_mask:0xf
v_sub_f32 v118, v118, v129
v_sub_f32 v119, v119, v129
v_add_f32_dpp v138, v138, v138 row_ror:1 row_mask:0xf bank_mask:0xf
v_sub_f32 v120, v120, v129
v_sub_f32 v121, v121, v129
v_add_f32_dpp v138, v138, v138 row_bcast:15 row_mask:0xa bank_mask:0xf
v_sub_f32 v122, v122, v129
v_sub_f32 v123, v123, v129
v_add_f32_dpp v138, v138, v138 row_bcast:31 row_mask:0xc bank_mask:0xf
v_sub_f32 v124, v124, v129
v_sub_f32 v125, v125, v129
v_sub_f32 v126, v126, v129
v_sub_f32 v127, v127, v129
v_readlane_b32 s37, v138, 63
v_mov_b32 v128, 0x3ae38e39
v_cvt_pk_bf16_f32 v130, v112, v113
v_cvt_pk_bf16_f32 v131, v114, v115
v_mul_f32 v128, s37, v128
v_cvt_pk_bf16_f32 v132, v116, v117
v_cvt_pk_bf16_f32 v128, v128, v128
v_cvt_pk_bf16_f32 v133, v118, v119
v_and_b32 v128, 0xffff0000, v128
v_cvt_pk_bf16_f32 v134, v120, v121
v_add_f32 v128, 0x3727c5ac, v128
v_cvt_pk_bf16_f32 v135, v122, v123
v_cvt_pk_bf16_f32 v128, v128, v128
v_cvt_pk_bf16_f32 v136, v124, v125
v_and_b32 v128, 0xffff0000, v128
v_cvt_pk_bf16_f32 v137, v126, v127
v_sqrt_f32 v128, v128
v_lshlrev_b32 v112, 16, v130
v_cvt_pk_bf16_f32 v128, v128, v128
v_and_b32 v113, 0xffff0000, v130
v_lshlrev_b32 v114, 16, v131
v_and_b32 v128, 0xffff0000, v128
v_and_b32 v115, 0xffff0000, v131
v_lshlrev_b32 v116, 16, v132
v_rcp_f32 v128, v128
v_and_b32 v117, 0xffff0000, v132
v_lshlrev_b32 v118, 16, v133
v_and_b32 v119, 0xffff0000, v133
v_lshlrev_b32 v120, 16, v134
v_and_b32 v121, 0xffff0000, v134
v_lshlrev_b32 v122, 16, v135
v_and_b32 v123, 0xffff0000, v135
v_lshlrev_b32 v124, 16, v136
v_and_b32 v125, 0xffff0000, v136
v_lshlrev_b32 v126, 16, v137
v_and_b32 v127, 0xffff0000, v137
v_mov_b32 v129, v128
v_pk_mul_f32 v[112:113], v[112:113], v[128:129]
v_pk_mul_f32 v[114:115], v[114:115], v[128:129]
v_pk_mul_f32 v[116:117], v[116:117], v[128:129]
v_pk_mul_f32 v[118:119], v[118:119], v[128:129]
v_pk_mul_f32 v[120:121], v[120:121], v[128:129]
v_pk_mul_f32 v[122:123], v[122:123], v[128:129]
v_pk_mul_f32 v[124:125], v[124:125], v[128:129]
v_pk_mul_f32 v[126:127], v[126:127], v[128:129]
v_lshlrev_b32 v108, 5, v1
v_add_u32 v108, 0, v108
v_cvt_pk_bf16_f32 v112, v112, v112
v_cvt_pk_bf16_f32 v113, v113, v113
v_cvt_pk_bf16_f32 v114, v114, v114
v_cvt_pk_bf16_f32 v115, v115, v115
ds_write_b128 v108, v[112:115]
v_cvt_pk_bf16_f32 v116, v116, v116
v_cvt_pk_bf16_f32 v117, v117, v117
v_cvt_pk_bf16_f32 v118, v118, v118
v_cvt_pk_bf16_f32 v119, v119, v119
ds_write_b128 v108, v[116:119] offset:16
v_cvt_pk_bf16_f32 v120, v120, v120
v_cvt_pk_bf16_f32 v121, v121, v121
v_cvt_pk_bf16_f32 v122, v122, v122
v_cvt_pk_bf16_f32 v123, v123, v123
v_cvt_pk_bf16_f32 v124, v124, v124
v_cvt_pk_bf16_f32 v125, v125, v125
v_cvt_pk_bf16_f32 v126, v126, v126
v_cvt_pk_bf16_f32 v127, v127, v127
s_mov_b32 exec_lo, 0xff
s_mov_b32 exec_hi, 0x0
ds_write_b128 v108, v[120:123] offset:2048
ds_write_b128 v108, v[124:127] offset:2064
s_mov_b64 exec, -1
s_mov_b32 s37, s40
L_nox_84:
s_waitcnt vmcnt(0)
ds_read_b128 v[140:143], v12 offset:0
ds_read_b128 v[156:159], v12 offset:256
ds_read_b128 v[144:147], v13 offset:0
ds_read_b128 v[160:163], v13 offset:256
ds_read_b128 v[148:151], v14 offset:0
ds_read_b128 v[164:167], v14 offset:256
ds_read_b128 v[152:155], v15 offset:0
ds_read_b128 v[168:171], v15 offset:256
s_cmp_lt_u32 s3, 4
s_cbranch_scc1 L_qps_87
L_qpa_85:
buffer_load_dwordx4 v[172:175], v9, s[28:31], s36 offen offset:0 sc1
buffer_load_dwordx4 v[176:179], v9, s[28:31], s36 offen offset:1024 sc1
buffer_load_dword v196, v10, s[28:31], s37 offen sc1
s_waitcnt vmcnt(0)
v_sad_u32 v196, v196, s92, 0
v_sad_u32 v196, v173, s92, v196
v_sad_u32 v196, v175, s92, v196
v_sad_u32 v196, v177, s92, v196
v_sad_u32 v196, v179, s92, v196
v_cmp_ne_u32 vcc, 0, v196
s_nop 0
s_cbranch_vccz L_qpo_86
s_cmp_eq_u32 s95, 0
s_cbranch_scc1 L_qpo_86
s_sub_u32 s95, s95, 1
s_branch L_qpa_85
L_qpo_86:
v_mov_b32 v173, v174
v_mov_b32 v177, v178
ds_write_b64 v198, v[172:173] offset:40960
ds_write_b64 v198, v[176:177] offset:41504
L_qps_87:
s_waitcnt lgkmcnt(0)
s_barrier
ds_read_b128 v[172:175], v199 offset:40960
ds_read_b128 v[176:179], v199 offset:41024
ds_read_b128 v[180:183], v199 offset:41088
ds_read_b128 v[184:187], v199 offset:41152
s_waitcnt lgkmcnt(3)
v_mfma_f32_16x16x32_bf16 v[188:191], v[172:175], v[140:143], 0
v_mfma_f32_16x16x32_bf16 v[192:195], v[172:175], v[156:159], 0
s_waitcnt lgkmcnt(2)
v_mfma_f32_16x16x32_bf16 v[188:191], v[176:179], v[144:147], v[188:191]
v_mfma_f32_16x16x32_bf16 v[192:195], v[176:179], v[160:163], v[192:195]
s_waitcnt lgkmcnt(1)
v_mfma_f32_16x16x32_bf16 v[188:191], v[180:183], v[148:151], v[188:191]
v_mfma_f32_16x16x32_bf16 v[192:195], v[180:183], v[164:167], v[192:195]
s_waitcnt lgkmcnt(0)
v_mfma_f32_16x16x32_bf16 v[188:191], v[184:187], v[152:155], v[188:191]
v_mfma_f32_16x16x32_bf16 v[192:195], v[184:187], v[168:171], v[192:195]
s_mov_b32 exec_lo, 0xffff
s_mov_b32 exec_hi, 0x0
s_nop 4
v_add_f32 v12, v188, v189
v_add_f32 v13, v190, v191
v_add_f32 v12, v12, v13
v_add_f32 v14, v192, v193
v_add_f32 v13, v194, v195
v_add_f32 v13, v14, v13
v_mul_f32 v12, s39, v12
v_mul_f32 v13, s39, v13
v_cvt_pk_bf16_f32 v12, v12, v13
buffer_store_dword v12, v11, s[28:31], s38 offen sc1
s_mov_b64 exec, -1
s_waitcnt lgkmcnt(0)
s_barrier
s_mov_b32 s8, s78
s_mov_b32 s9, s79
s_mov_b32 s10, 5308416
s_mov_b32 s11, 0x20000
s_mov_b32 s12, s82
s_mov_b32 s13, s83
s_mov_b32 s14, 5308416
s_mov_b32 s15, 0x20000
s_mov_b32 s16, s80
s_mov_b32 s17, s81
s_mov_b32 s18, 9216
s_mov_b32 s19, 0x20000
s_sub_u32 s34, s94, 8
s_lshl_b32 s40, s93, 3
s_add_u32 s40, s40, s34
s_mul_i32 s35, s40, 72
v_mul_u32_u24 v8, 9216, v3
v_lshl_add_u32 v8, v2, 4, v8
s_mul_i32 s36, s3, 663552
s_lshl_b32 s37, s35, 1
s_add_u32 s36, s36, s37
s_mov_b32 exec_lo, 0x1ff01ff
s_mov_b32 exec_hi, 0x1ff01ff
buffer_load_dwordx4 v[16:19], v8, s[8:11], s36 offen nt
s_add_u32 s36, s36, 36864
buffer_load_dwordx4 v[20:23], v8, s[8:11], s36 offen nt
s_add_u32 s36, s36, 36864
buffer_load_dwordx4 v[24:27], v8, s[8:11], s36 offen nt
s_add_u32 s36, s36, 36864
buffer_load_dwordx4 v[28:31], v8, s[8:11], s36 offen nt
s_add_u32 s36, s36, 36864
buffer_load_dwordx4 v[32:35], v8, s[8:11], s36 offen nt
s_add_u32 s36, s36, 36864
buffer_load_dwordx4 v[36:39], v8, s[8:11], s36 offen nt
s_add_u32 s36, s36, 36864
buffer_load_dwordx4 v[40:43], v8, s[8:11], s36 offen nt
s_add_u32 s36, s36, 36864
buffer_load_dwordx4 v[44:47], v8, s[8:11], s36 offen nt
s_add_u32 s36, s36, 36864
buffer_load_dwordx4 v[48:51], v8, s[8:11], s36 offen nt
s_add_u32 s36, s36, 36864
buffer_load_dwordx4 v[52:55], v8, s[8:11], s36 offen nt
s_add_u32 s36, s36, 36864
s_waitcnt vmcnt(9)
buffer_load_dwordx4 v[56:59], v8, s[8:11], s36 offen nt
s_add_u32 s36, s36, 36864
s_waitcnt vmcnt(9)
buffer_load_dwordx4 v[60:63], v8, s[8:11], s36 offen nt
s_add_u32 s36, s36, 36864
s_waitcnt vmcnt(9)
buffer_load_dwordx4 v[64:67], v8, s[8:11], s36 offen nt
s_add_u32 s36, s36, 36864
s_waitcnt vmcnt(9)
buffer_load_dwordx4 v[68:71], v8, s[8:11], s36 offen nt
s_add_u32 s36, s36, 36864
s_waitcnt vmcnt(9)
buffer_load_dwordx4 v[72:75], v8, s[8:11], s36 offen nt
s_add_u32 s36, s36, 36864
s_waitcnt vmcnt(9)
buffer_load_dwordx4 v[76:79], v8, s[8:11], s36 offen nt
s_add_u32 s36, s36, 36864
s_waitcnt vmcnt(9)
buffer_load_dwordx4 v[80:83], v8, s[8:11], s36 offen nt
s_add_u32 s36, s36, 36864
s_waitcnt vmcnt(9)
buffer_load_dwordx4 v[84:87], v8, s[8:11], s36 offen nt
s_mov_b64 exec, -1
v_min_u32 v13, 2, v2
v_lshl_add_u32 v13, v13, 2, v3
v_min_u32 v13, 8, v13
s_mul_i32 s36, s3, 9
v_add_u32 v13, s36, v13
v_lshlrev_b32 v9, 1, v13
buffer_load_ushort v204, v9, s[16:19], s37 offen
v_lshlrev_b32 v10, 2, v1
v_add_u32 v10, 8192, v10
buffer_load_dword v212, v10, s[28:31], 0 offen sc1
v_lshlrev_b32 v13, 2, v13
v_mul_u32_u24 v8, 1152, v3
v_lshl_add_u32 v8, v2, 4, v8
v_lshlrev_b32 v12, 28, v3
v_lshl_add_u32 v12, v2, 4, v12
s_add_u32 s36, s36, s35
s_mul_i32 s36, s36, 1152
s_mul_i32 s38, s3, 288
v_lshl_add_u32 v9, v2, 2, v3
v_lshl_add_u32 v9, v9, 2, s38
ds_read_b32 v152, v9 offset:0
v_and_b32 v9, 1, v2
v_lshl_add_u32 v9, v9, 2, v3
v_lshl_add_u32 v9, v9, 2, s38
ds_read_b32 v153, v9 offset:256
v_lshlrev_b32 v9, 5, v2
v_lshl_add_u32 v9, v3, 4, v9
s_lshl_b32 s37, s3, 9
v_add_u32 v11, s37, v9
s_waitcnt lgkmcnt(0)
v_and_b32_dpp v172, v152, v4 row_newbcast:0 row_mask:0xf bank_mask:0xf
v_and_b32_dpp v173, v152, v5 row_newbcast:0 row_mask:0xf bank_mask:0xf
v_and_b32_dpp v174, v152, v6 row_newbcast:0 row_mask:0xf bank_mask:0xf
v_and_b32_dpp v175, v152, v7 row_newbcast:0 row_mask:0xf bank_mask:0xf
s_barrier
v_and_b32_dpp v176, v152, v4 row_newbcast:1 row_mask:0xf bank_mask:0xf
v_and_b32_dpp v177, v152, v5 row_newbcast:1 row_mask:0xf bank_mask:0xf
v_and_b32_dpp v178, v152, v6 row_newbcast:1 row_mask:0xf bank_mask:0xf
v_and_b32_dpp v179, v152, v7 row_newbcast:1 row_mask:0xf bank_mask:0xf
s_waitcnt vmcnt(19)
v_mfma_f32_16x16x32_bf16 v[184:187], v[172:175], v[16:19], 0
v_and_b32_dpp v180, v152, v4 row_newbcast:2 row_mask:0xf bank_mask:0xf
v_and_b32_dpp v181, v152, v5 row_newbcast:2 row_mask:0xf bank_mask:0xf
v_and_b32_dpp v182, v152, v6 row_newbcast:2 row_mask:0xf bank_mask:0xf
v_and_b32_dpp v183, v152, v7 row_newbcast:2 row_mask:0xf bank_mask:0xf
s_waitcnt vmcnt(18)
v_mfma_f32_16x16x32_bf16 v[184:187], v[176:179], v[20:23], v[184:187]
v_and_b32_dpp v172, v152, v4 row_newbcast:3 row_mask:0xf bank_mask:0xf
v_and_b32_dpp v173, v152, v5 row_newbcast:3 row_mask:0xf bank_mask:0xf
v_and_b32_dpp v174, v152, v6 row_newbcast:3 row_mask:0xf bank_mask:0xf
v_and_b32_dpp v175, v152, v7 row_newbcast:3 row_mask:0xf bank_mask:0xf
s_waitcnt vmcnt(17)
v_mfma_f32_16x16x32_bf16 v[184:187], v[180:183], v[24:27], v[184:187]
v_and_b32_dpp v176, v152, v4 row_newbcast:4 row_mask:0xf bank_mask:0xf
v_and_b32_dpp v177, v152, v5 row_newbcast:4 row_mask:0xf bank_mask:0xf
v_and_b32_dpp v178, v152, v6 row_newbcast:4 row_mask:0xf bank_mask:0xf
v_and_b32_dpp v179, v152, v7 row_newbcast:4 row_mask:0xf bank_mask:0xf
s_waitcnt vmcnt(16)
v_mfma_f32_16x16x32_bf16 v[184:187], v[172:175], v[28:31], v[184:187]
buffer_load_dwordx4 v[88:91], v8, s[12:15], s36 offen offset:0 nt
v_and_b32_dpp v180, v152, v4 row_newbcast:5 row_mask:0xf bank_mask:0xf
v_and_b32_dpp v181, v152, v5 row_newbcast:5 row_mask:0xf bank_mask:0xf
v_and_b32_dpp v182, v152, v6 row_newbcast:5 row_mask:0xf bank_mask:0xf
v_and_b32_dpp v183, v152, v7 row_newbcast:5 row_mask:0xf bank_mask:0xf
s_waitcnt vmcnt(16)
v_mfma_f32_16x16x32_bf16 v[184:187], v[176:179], v[32:35], v[184:187]
buffer_load_dwordx4 v[92:95], v8, s[12:15], s36 offen offset:256 nt
v_and_b32_dpp v172, v152, v4 row_newbcast:6 row_mask:0xf bank_mask:0xf
v_and_b32_dpp v173, v152, v5 row_newbcast:6 row_mask:0xf bank_mask:0xf
v_and_b32_dpp v174, v152, v6 row_newbcast:6 row_mask:0xf bank_mask:0xf
v_and_b32_dpp v175, v152, v7 row_newbcast:6 row_mask:0xf bank_mask:0xf
s_waitcnt vmcnt(16)
v_mfma_f32_16x16x32_bf16 v[184:187], v[180:183], v[36:39], v[184:187]
buffer_load_dwordx4 v[96:99], v8, s[12:15], s36 offen offset:512 nt
v_and_b32_dpp v176, v152, v4 row_newbcast:7 row_mask:0xf bank_mask:0xf
v_and_b32_dpp v177, v152, v5 row_newbcast:7 row_mask:0xf bank_mask:0xf
v_and_b32_dpp v178, v152, v6 row_newbcast:7 row_mask:0xf bank_mask:0xf
v_and_b32_dpp v179, v152, v7 row_newbcast:7 row_mask:0xf bank_mask:0xf
s_waitcnt vmcnt(16)
v_mfma_f32_16x16x32_bf16 v[184:187], v[172:175], v[40:43], v[184:187]
buffer_load_dwordx4 v[100:103], v8, s[12:15], s36 offen offset:768 nt
v_and_b32_dpp v180, v152, v4 row_newbcast:8 row_mask:0xf bank_mask:0xf
v_and_b32_dpp v181, v152, v5 row_newbcast:8 row_mask:0xf bank_mask:0xf
v_and_b32_dpp v182, v152, v6 row_newbcast:8 row_mask:0xf bank_mask:0xf
v_and_b32_dpp v183, v152, v7 row_newbcast:8 row_mask:0xf bank_mask:0xf
s_waitcnt vmcnt(16)
v_mfma_f32_16x16x32_bf16 v[184:187], v[176:179], v[44:47], v[184:187]
s_mov_b32 exec_lo, 0xff00ff
s_mov_b32 exec_hi, 0xff00ff
buffer_load_dwordx4 v[104:107], v8, s[12:15], s36 offen offset:1024 nt
s_mov_b64 exec, -1
s_add_u32 s36, s36, 4608
v_and_b32_dpp v172, v152, v4 row_newbcast:9 row_mask:0xf bank_mask:0xf
v_and_b32_dpp v173, v152, v5 row_newbcast:9 row_mask:0xf bank_mask:0xf
v_and_b32_dpp v174, v152, v6 row_newbcast:9 row_mask:0xf bank_mask:0xf
v_and_b32_dpp v175, v152, v7 row_newbcast:9 row_mask:0xf bank_mask:0xf
s_waitcnt vmcnt(16)
v_mfma_f32_16x16x32_bf16 v[184:187], v[180:183], v[48:51], v[184:187]
buffer_load_dwordx4 v[108:111], v8, s[12:15], s36 offen offset:0 nt
v_and_b32_dpp v176, v152, v4 row_newbcast:10 row_mask:0xf bank_mask:0xf
v_and_b32_dpp v177, v152, v5 row_newbcast:10 row_mask:0xf bank_mask:0xf
v_and_b32_dpp v178, v152, v6 row_newbcast:10 row_mask:0xf bank_mask:0xf
v_and_b32_dpp v179, v152, v7 row_newbcast:10 row_mask:0xf bank_mask:0xf
s_waitcnt vmcnt(16)
v_mfma_f32_16x16x32_bf16 v[184:187], v[172:175], v[52:55], v[184:187]
buffer_load_dwordx4 v[112:115], v8, s[12:15], s36 offen offset:256 nt
v_and_b32_dpp v180, v152, v4 row_newbcast:11 row_mask:0xf bank_mask:0xf
v_and_b32_dpp v181, v152, v5 row_newbcast:11 row_mask:0xf bank_mask:0xf
v_and_b32_dpp v182, v152, v6 row_newbcast:11 row_mask:0xf bank_mask:0xf
v_and_b32_dpp v183, v152, v7 row_newbcast:11 row_mask:0xf bank_mask:0xf
s_waitcnt vmcnt(16)
v_mfma_f32_16x16x32_bf16 v[184:187], v[176:179], v[56:59], v[184:187]
buffer_load_dwordx4 v[116:119], v8, s[12:15], s36 offen offset:512 nt
v_and_b32_dpp v172, v152, v4 row_newbcast:12 row_mask:0xf bank_mask:0xf
v_and_b32_dpp v173, v152, v5 row_newbcast:12 row_mask:0xf bank_mask:0xf
v_and_b32_dpp v174, v152, v6 row_newbcast:12 row_mask:0xf bank_mask:0xf
v_and_b32_dpp v175, v152, v7 row_newbcast:12 row_mask:0xf bank_mask:0xf
s_waitcnt vmcnt(16)
v_mfma_f32_16x16x32_bf16 v[184:187], v[180:183], v[60:63], v[184:187]
buffer_load_dwordx4 v[120:123], v8, s[12:15], s36 offen offset:768 nt
v_and_b32_dpp v176, v152, v4 row_newbcast:13 row_mask:0xf bank_mask:0xf
v_and_b32_dpp v177, v152, v5 row_newbcast:13 row_mask:0xf bank_mask:0xf
v_and_b32_dpp v178, v152, v6 row_newbcast:13 row_mask:0xf bank_mask:0xf
v_and_b32_dpp v179, v152, v7 row_newbcast:13 row_mask:0xf bank_mask:0xf
s_waitcnt vmcnt(16)
v_mfma_f32_16x16x32_bf16 v[184:187], v[172:175], v[64:67], v[184:187]
s_mov_b32 exec_lo, 0xff00ff
s_mov_b32 exec_hi, 0xff00ff
buffer_load_dwordx4 v[124:127], v8, s[12:15], s36 offen offset:1024 nt
s_mov_b64 exec, -1
s_add_u32 s36, s36, 4608
v_and_b32_dpp v180, v152, v4 row_newbcast:14 row_mask:0xf bank_mask:0xf
v_and_b32_dpp v181, v152, v5 row_newbcast:14 row_mask:0xf bank_mask:0xf
v_and_b32_dpp v182, v152, v6 row_newbcast:14 row_mask:0xf bank_mask:0xf
v_and_b32_dpp v183, v152, v7 row_newbcast:14 row_mask:0xf bank_mask:0xf
s_waitcnt vmcnt(16)
v_mfma_f32_16x16x32_bf16 v[184:187], v[176:179], v[68:71], v[184:187]
buffer_load_dwordx4 v[128:131], v12, s[12:15], s36 offen offset:0 nt
v_and_b32_dpp v172, v152, v4 row_newbcast:15 row_mask:0xf bank_mask:0xf
v_and_b32_dpp v173, v152, v5 row_newbcast:15 row_mask:0xf bank_mask:0xf
v_and_b32_dpp v174, v152, v6 row_newbcast:15 row_mask:0xf bank_mask:0xf
v_and_b32_dpp v175, v152, v7 row_newbcast:15 row_mask:0xf bank_mask:0xf
s_waitcnt vmcnt(16)
v_mfma_f32_16x16x32_bf16 v[184:187], v[180:183], v[72:75], v[184:187]
buffer_load_dwordx4 v[132:135], v12, s[12:15], s36 offen offset:256 nt
v_and_b32_dpp v176, v153, v4 row_newbcast:0 row_mask:0xf bank_mask:0xf
v_and_b32_dpp v177, v153, v5 row_newbcast:0 row_mask:0xf bank_mask:0xf
v_and_b32_dpp v178, v153, v6 row_newbcast:0 row_mask:0xf bank_mask:0xf
v_and_b32_dpp v179, v153, v7 row_newbcast:0 row_mask:0xf bank_mask:0xf
s_waitcnt vmcnt(16)
v_mfma_f32_16x16x32_bf16 v[184:187], v[172:175], v[76:79], v[184:187]
buffer_load_dwordx4 v[136:139], v12, s[12:15], s36 offen offset:512 nt
v_and_b32_dpp v180, v153, v4 row_newbcast:1 row_mask:0xf bank_mask:0xf
v_and_b32_dpp v181, v153, v5 row_newbcast:1 row_mask:0xf bank_mask:0xf
v_and_b32_dpp v182, v153, v6 row_newbcast:1 row_mask:0xf bank_mask:0xf
v_and_b32_dpp v183, v153, v7 row_newbcast:1 row_mask:0xf bank_mask:0xf
s_waitcnt vmcnt(16)
v_mfma_f32_16x16x32_bf16 v[184:187], v[176:179], v[80:83], v[184:187]
buffer_load_dwordx4 v[140:143], v12, s[12:15], s36 offen offset:768 nt
s_waitcnt vmcnt(16)
v_mfma_f32_16x16x32_bf16 v[184:187], v[180:183], v[84:87], v[184:187]
s_mov_b32 exec_lo, 0xff00ff
s_mov_b32 exec_hi, 0xff00ff
buffer_load_dwordx4 v[144:147], v12, s[12:15], s36 offen offset:1024 nt
s_mov_b64 exec, -1
s_mov_b32 exec_lo, 0x1ff01ff
s_mov_b32 exec_hi, 0x0
s_nop 1
ds_write_b128 v11, v[184:187] offset:8192
s_mov_b64 exec, -1
s_mov_b32 s38, 0xff00ff00
s_mov_b32 s39, 0xff00ff00
v_cndmask_b32 v232, v4, 0, s[38:39]
v_cndmask_b32 v236, 0, v4, s[38:39]
v_cndmask_b32 v233, v5, 0, s[38:39]
v_cndmask_b32 v237, 0, v5, s[38:39]
v_cndmask_b32 v234, v6, 0, s[38:39]
v_cndmask_b32 v238, 0, v6, s[38:39]
v_cndmask_b32 v235, v7, 0, s[38:39]
v_cndmask_b32 v239, 0, v7, s[38:39]
v_and_b32 v12, 1, v3
v_lshlrev_b32 v229, 5, v2
v_lshl_add_u32 v229, v12, 4, v229
v_lshrrev_b32 v12, 1, v3
v_lshl_add_u32 v229, v12, 9, v229
s_mul_i32 s37, s3, 2304
v_add_u32 v229, s37, v229
s_lshl_b32 s32, s3, 10
v_lshl_add_u32 v230, v1, 4, s32
v_lshrrev_b32 v231, 7, v230
v_lshlrev_b32 v231, 13, v231
v_and_b32 v251, 0x70, v230
v_add_u32 v231, v231, v251
s_lshl_b32 s41, s40, 7
s_add_u32 s41, s41, 671744
s_cmp_lt_u32 s3, 2
s_cselect_b32 s42, -1, 0xffff
s_cselect_b32 s43, -1, 0
s_waitcnt vmcnt(15)
s_branch L_flc_90
L_fla_88:
buffer_load_dword v212, v10, s[28:31], 0 offen sc1
s_waitcnt vmcnt(0)
L_flc_90:
v_cmp_ne_u32 vcc, s92, v212
s_nop 0
s_cbranch_vccz L_flo_89
s_cmp_eq_u32 s95, 0
s_cbranch_scc1 L_flo_89
s_sub_u32 s95, s95, 1
s_branch L_fla_88
L_flo_89:
s_waitcnt lgkmcnt(0)
s_barrier
ds_read2st64_b32 v[16:17], v13 offset0:32 offset1:34
ds_read2st64_b32 v[18:19], v13 offset0:36 offset1:38
ds_read2st64_b32 v[20:21], v13 offset0:40 offset1:42
ds_read2st64_b32 v[22:23], v13 offset0:44 offset1:46
s_mov_b32 s38, 0xc0135761
s_mov_b32 s39, 0xbdd2d3e8
s_waitcnt vmcnt(16)
v_lshlrev_b32 v204, 16, v204
s_waitcnt lgkmcnt(0)
v_pk_add_f32 v[16:17], v[16:17], v[18:19]
v_pk_add_f32 v[20:21], v[20:21], v[22:23]
v_pk_add_f32 v[16:17], v[16:17], v[20:21]
v_add_f32 v16, v16, v17
v_cvt_pk_bf16_f32 v16, v16, v16
v_and_b32 v16, 0xffff0000, v16
v_add_f32 v16, v16, v204
v_cvt_pk_bf16_f32 v16, v16, v16
v_and_b32 v16, 0xffff0000, v16
v_mul_f32 v18, v16, v16
v_mul_f32 v18, s39, v18
v_add_f32 v18, s38, v18
v_mul_f32 v18, v18, v16
v_exp_f32 v18, v18
s_nop 0
v_add_f32 v18, 1.0, v18
v_rcp_f32 v18, v18
s_nop 0
v_mul_f32 v16, v16, v18
v_cvt_pk_bf16_f32 v152, v16, v16
s_nop 1
v_and_b32_dpp v24, v152, v232 row_newbcast:0 row_mask:0xf bank_mask:0xf
v_and_b32_dpp v25, v152, v233 row_newbcast:0 row_mask:0xf bank_mask:0xf
v_and_b32_dpp v26, v152, v234 row_newbcast:0 row_mask:0xf bank_mask:0xf
v_and_b32_dpp v27, v152, v235 row_newbcast:0 row_mask:0xf bank_mask:0xf
v_and_b32_dpp v28, v152, v236 row_newbcast:0 row_mask:0xf bank_mask:0xf
v_and_b32_dpp v29, v152, v237 row_newbcast:0 row_mask:0xf bank_mask:0xf
v_and_b32_dpp v30, v152, v238 row_newbcast:0 row_mask:0xf bank_mask:0xf
v_and_b32_dpp v31, v152, v239 row_newbcast:0 row_mask:0xf bank_mask:0xf
v_and_b32_dpp v32, v152, v232 row_newbcast:1 row_mask:0xf bank_mask:0xf
v_and_b32_dpp v33, v152, v233 row_newbcast:1 row_mask:0xf bank_mask:0xf
v_and_b32_dpp v34, v152, v234 row_newbcast:1 row_mask:0xf bank_mask:0xf
v_and_b32_dpp v35, v152, v235 row_newbcast:1 row_mask:0xf bank_mask:0xf
v_and_b32_dpp v36, v152, v236 row_newbcast:1 row_mask:0xf bank_mask:0xf
v_and_b32_dpp v37, v152, v237 row_newbcast:1 row_mask:0xf bank_mask:0xf
v_and_b32_dpp v38, v152, v238 row_newbcast:1 row_mask:0xf bank_mask:0xf
v_and_b32_dpp v39, v152, v239 row_newbcast:1 row_mask:0xf bank_mask:0xf
v_and_b32_dpp v40, v152, v232 row_newbcast:2 row_mask:0xf bank_mask:0xf
v_and_b32_dpp v41, v152, v233 row_newbcast:2 row_mask:0xf bank_mask:0xf
v_and_b32_dpp v42, v152, v234 row_newbcast:2 row_mask:0xf bank_mask:0xf
v_and_b32_dpp v43, v152, v235 row_newbcast:2 row_mask:0xf bank_mask:0xf
v_and_b32_dpp v44, v152, v236 row_newbcast:2 row_mask:0xf bank_mask:0xf
v_and_b32_dpp v45, v152, v237 row_newbcast:2 row_mask:0xf bank_mask:0xf
v_and_b32_dpp v46, v152, v238 row_newbcast:2 row_mask:0xf bank_mask:0xf
v_and_b32_dpp v47, v152, v239 row_newbcast:2 row_mask:0xf bank_mask:0xf
s_waitcnt vmcnt(14)
v_mfma_f32_16x16x32_bf16 v[184:187], v[24:27], v[88:91], 0
s_waitcnt vmcnt(13)
v_mfma_f32_16x16x32_bf16 v[184:187], v[28:31], v[92:95], v[184:187]
s_waitcnt vmcnt(12)
v_mfma_f32_16x16x32_bf16 v[188:191], v[24:27], v[96:99], 0
s_waitcnt vmcnt(11)
v_mfma_f32_16x16x32_bf16 v[188:191], v[28:31], v[100:103], v[188:191]
s_waitcnt vmcnt(10)
v_mfma_f32_16x16x32_bf16 v[192:195], v[24:27], v[104:107], 0
s_waitcnt vmcnt(9)
v_mfma_f32_16x16x32_bf16 v[184:187], v[32:35], v[108:111], v[184:187]
s_waitcnt vmcnt(8)
v_mfma_f32_16x16x32_bf16 v[184:187], v[36:39], v[112:115], v[184:187]
s_waitcnt vmcnt(7)
v_mfma_f32_16x16x32_bf16 v[188:191], v[32:35], v[116:119], v[188:191]
s_waitcnt vmcnt(6)
v_mfma_f32_16x16x32_bf16 v[188:191], v[36:39], v[120:123], v[188:191]
s_waitcnt vmcnt(5)
v_mfma_f32_16x16x32_bf16 v[192:195], v[32:35], v[124:127], v[192:195]
s_waitcnt vmcnt(4)
v_mfma_f32_16x16x32_bf16 v[184:187], v[40:43], v[128:131], v[184:187]
s_waitcnt vmcnt(3)
v_mfma_f32_16x16x32_bf16 v[184:187], v[44:47], v[132:135], v[184:187]
s_waitcnt vmcnt(2)
v_mfma_f32_16x16x32_bf16 v[188:191], v[40:43], v[136:139], v[188:191]
s_waitcnt vmcnt(1)
v_mfma_f32_16x16x32_bf16 v[188:191], v[44:47], v[140:143], v[188:191]
s_waitcnt vmcnt(0)
v_mfma_f32_16x16x32_bf16 v[192:195], v[40:43], v[144:147], v[192:195]
s_nop 1
ds_write_b128 v229, v[184:187] offset:16384
s_nop 2
ds_write_b128 v229, v[188:191] offset:17408
s_mov_b32 exec_lo, 0xff00ff
s_mov_b32 exec_hi, 0x0
ds_write_b128 v229, v[192:195] offset:18432
s_mov_b64 exec, -1
s_waitcnt lgkmcnt(0)
s_barrier
s_cmp_ge_u32 s3, 3
s_cbranch_scc1 L_rp_91
s_mov_b64 exec, s[42:43]
ds_read_b128 v[16:19], v230 offset:16384
ds_read_b128 v[20:23], v230 offset:18688
ds_read_b128 v[24:27], v230 offset:20992
ds_read_b128 v[28:31], v230 offset:23296
ds_read_b128 v[32:35], v230 offset:25600
ds_read_b128 v[36:39], v230 offset:27904
ds_read_b128 v[40:43], v230 offset:30208
ds_read_b128 v[44:47], v230 offset:32512
s_waitcnt lgkmcnt(6)
v_pk_add_f32 v[16:17], v[16:17], v[20:21]
v_pk_add_f32 v[18:19], v[18:19], v[22:23]
s_waitcnt lgkmcnt(4)
v_pk_add_f32 v[24:25], v[24:25], v[28:29]
v_pk_add_f32 v[26:27], v[26:27], v[30:31]
v_pk_add_f32 v[16:17], v[16:17], v[24:25]
v_pk_add_f32 v[18:19], v[18:19], v[26:27]
s_waitcnt lgkmcnt(2)
v_pk_add_f32 v[32:33], v[32:33], v[36:37]
v_pk_add_f32 v[34:35], v[34:35], v[38:39]
s_waitcnt lgkmcnt(0)
v_pk_add_f32 v[40:41], v[40:41], v[44:45]
v_pk_add_f32 v[42:43], v[42:43], v[46:47]
v_pk_add_f32 v[32:33], v[32:33], v[40:41]
v_pk_add_f32 v[34:35], v[34:35], v[42:43]
v_pk_add_f32 v[16:17], v[16:17], v[32:33]
v_pk_add_f32 v[18:19], v[18:19], v[34:35]
buffer_store_dwordx4 v[16:19], v231, s[28:31], s41 offen sc1
s_mov_b64 exec, -1
L_rp_91:
s_endpgm
L_exit:
s_endpgm
.fill (1024-((.-recurrent_scan__compressed_kv_cla__dense_activation_gelu__decode_kernel)%1024))/4, 4, 0xbf800000
L_codeend:
.section .rodata,"a"
.p2align 6
.amdhsa_kernel recurrent_scan__compressed_kv_cla__dense_activation_gelu__decode_kernel
  .amdhsa_next_free_vgpr 256
  .amdhsa_next_free_sgpr 102
  .amdhsa_accum_offset 256
  .amdhsa_group_segment_fixed_size 0
  .amdhsa_kernarg_size 112
  .amdhsa_user_sgpr_count 2
  .amdhsa_user_sgpr_kernarg_segment_ptr 1
  .amdhsa_system_sgpr_workgroup_id_x 1
  .amdhsa_float_denorm_mode_32 3
.end_amdhsa_kernel
```
